```python
import torch

def _softmax(x, axis=-1):
    return torch.softmax(x, dim=axis)
def _gelu(x):
    return torch.nn.functional.gelu(x, approximate="tanh")
def _silu(x):
    return torch.nn.functional.silu(x)
def _sigmoid(x):
    return torch.sigmoid(x)
def _layernorm(x, axis=-1, eps=1e-5):
    m = x.mean(dim=axis, keepdim=True)
    v = x.var(dim=axis, keepdim=True, unbiased=False)
    return (x - m) / torch.sqrt(v + eps)
def _scatter_add(tgt, idx, src, axis=0):
    return tgt.clone().index_add_(axis, idx, src)
def _segment_sum(src, seg, n):
    out = torch.zeros((n,) + src.shape[1:], dtype=src.dtype)
    return out.index_add_(0, seg, src)
def _pad(x, pw):
    flat = tuple(v for pair in reversed(pw) for v in pair)
    return torch.nn.functional.pad(x, flat)

kernel_name = 'gated_mix__spectral_fnet__mha_block__prompt'

def setup_inputs():

    _w = (lambda a: (lambda t: t.to(torch.bfloat16) if t.is_floating_point() else t)(torch.as_tensor(a)))
    def _A_setup():
        B, S, D = 1, 2048, 640
        ns = torch.arange(S)[:, None] * torch.arange(S)[None, :]
        nd = torch.arange(D)[:, None] * torch.arange(D)[None, :]
        Ws_re = torch.cos(-2.0 * torch.pi * ns / S).to(float)
        Ws_im = torch.sin(-2.0 * torch.pi * ns / S).to(float)
        Wd_re = torch.cos(-2.0 * torch.pi * nd / D).to(float)
        Wd_im = torch.sin(-2.0 * torch.pi * nd / D).to(float)
        return {
            "x": _w((lambda *s: torch.randn(*s, dtype=torch.bfloat16) * 0.05)(B, S, D)),
            "dft_seq_re": _w(Ws_re),
            "dft_seq_im": _w(Ws_im),
            "dft_hid_re": _w(Wd_re),
            "dft_hid_im": _w(Wd_im),
        }
    _A_in = _A_setup()

    def _B_setup():
        B, S, D, H = 1, 2048, 640, 32
        return {
            "x": _w((lambda *s: torch.randn(*s, dtype=torch.bfloat16) * 0.05)(B, S, D)),
            "wqkv": _w((lambda *s: torch.randn(*s, dtype=torch.bfloat16) * 1.6)(D, 3 * D)),
            "wo": _w((lambda *s: torch.randn(*s, dtype=torch.bfloat16) * 1.6)(D, D)),
        }
    _B_in = _B_setup()

    return {
        "A_x": _A_in["x"],
        "A_dft_seq_re": _A_in["dft_seq_re"],
        "A_dft_seq_im": _A_in["dft_seq_im"],
        "A_dft_hid_re": _A_in["dft_hid_re"],
        "A_dft_hid_im": _A_in["dft_hid_im"],
        "B_x": _B_in["x"],
        "B_wqkv": _B_in["wqkv"],
        "B_wo": _B_in["wo"],
        "gate_w": _w((lambda *s: torch.randn(*s, dtype=torch.bfloat16) * 0.05)(640) * 16.0),
    }

def reference(A_x, A_dft_seq_re, A_dft_seq_im, A_dft_hid_re, A_dft_hid_im, B_x, B_wqkv, B_wo, gate_w):
    def _A_ref(x, dft_seq_re, dft_seq_im, dft_hid_re, dft_hid_im):
        a = torch.einsum("bsd,ed->bse", x, dft_hid_re)
        b = torch.einsum("bsd,ed->bse", x, dft_hid_im)
        y = torch.einsum("ts,bse->bte", dft_seq_re, a) - torch.einsum("ts,bse->bte", dft_seq_im, b)
        return y

    def _B_ref(x, wqkv, wo):
        B, S, D = x.shape
        H = 32
        Dh = D // H
        qkv = (lambda x, *d: x.permute(*d))((x @ wqkv).reshape(B, S, 3, H, Dh), 2, 0, 3, 1, 4)
        q, k, v = qkv[0], qkv[1], qkv[2]
        scores = torch.einsum("bhqd,bhkd->bhqk", q, k) * (Dh ** -0.5)
        p = _softmax(scores, axis=-1)
        o = torch.einsum("bhqk,bhkd->bhqd", p, v)
        return (lambda x, *d: x.permute(*d))(o, 0, 2, 1, 3).reshape(B, S, D) @ wo

    x = A_x
    g = _sigmoid((x * gate_w).sum(-1, keepdims=True))
    a = _A_ref(x, A_dft_seq_re, A_dft_seq_im, A_dft_hid_re, A_dft_hid_im)
    b = _B_ref(x, B_wqkv, B_wo)
    return g * a + (1 - g) * b
```

```asm
; @launch grid=(256,1,1) block=(768,1,1) lds=163840
.amdgcn_target "amdgcn-amd-amdhsa--gfx950"
.text
    .globl gated_mix__spectral_fnet__mha_block__prompt_kernel
    .p2align 8
    .type gated_mix__spectral_fnet__mha_block__prompt_kernel,@function
gated_mix__spectral_fnet__mha_block__prompt_kernel:
    s_cmp_ge_u32 s2, 256
    s_cbranch_scc1 K2_EXIT
    s_load_dwordx2 s[4:5], s[0:1], 0
    s_load_dwordx4 s[20:23], s[0:1], 24
    s_load_dwordx4 s[24:27], s[0:1], 48
    s_load_dwordx2 s[28:29], s[0:1], 64
    s_load_dwordx2 s[30:31], s[0:1], 88
    v_lshrrev_b32 v1, 6, v0
    v_and_b32 v0, 63, v0
    s_and_b32 s46, s2, 7
    s_lshr_b32 s47, s2, 3
    v_readfirstlane_b32 s34, v1
    s_and_b32 s32, s47, 15
    s_lshr_b32 s33, s47, 4
    s_mov_b32 s3, s34
    s_mov_b32 s70, 0
    s_mov_b32 s69, 0
    s_lshl_b32 s71, s33, 1
    s_add_u32 s71, s71, 2
    s_cmp_lt_u32 s34, 4
    s_cbranch_scc1 K1_COMPUTE
    s_cmp_ge_u32 s34, 8
    s_cbranch_scc1 K1_AUX
    s_sub_u32 s34, s34, 4
    s_mul_i32 s38, s33, 0
    s_add_u32 s38, s38, s32
    s_mul_i32 s39, s46, 1
    s_add_u32 s38, s38, s39
    s_mul_i32 s39, s38, 26
    s_lshr_b32 s39, s39, 8
    s_mul_i32 s39, s39, 10
    s_sub_u32 s38, s38, s39
    s_lshr_b32 s35, s34, 1
    s_lshl_b32 s49, s33, 1
    s_add_u32 s35, s35, s49
    s_movk_i32 s54, 1280
    s_movk_i32 s55, 3840
    s_mul_i32 s56, s35, 1280
    s_mul_i32 s57, s46, 160
    s_add_u32 s56, s56, s57
    s_and_b32 s57, s46, 3
    s_mul_i32 s57, s57, 160
    s_cmp_eq_u32 s35, 3
    s_cselect_b32 s36, s54, s55
    s_cselect_b32 s37, s57, s56
    v_lshrrev_b32 v1, 3, v0
    v_and_b32 v2, 7, v0
    v_lshrrev_b32 v3, 4, v0
    v_xor_b32 v4, v2, v3
    v_lshlrev_b32 v4, 4, v4
    s_and_b32 s49, s34, 1
    s_lshl_b32 s50, s49, 6
    v_xor_b32 v4, s50, v4
    v_xor_b32 v5, 64, v4
    s_movk_i32 s48, 1280
    s_lshl_b32 s50, s32, 6
    s_lshl_b32 s51, s34, 3
    s_add_u32 s50, s50, s51
    v_and_b32 v6, 3, v1
    v_and_b32 v7, 32, v0
    v_add3_u32 v6, v6, v7, s50
    v_add_u32 v7, 4, v6
    v_sub_u32 v8, 2048, v6
    v_sub_u32 v9, 2048, v7
    v_cmp_eq_u32 vcc, 0, v6
    v_mov_b32 v14, 1024
    v_mul_u32_u24 v6, s48, v6
    v_mul_u32_u24 v7, s48, v7
    v_cndmask_b32 v8, v8, v14, vcc
    v_mul_u32_u24 v9, s48, v9
    v_mul_u32_u24 v8, s48, v8
    v_add_u32 v10, v6, v4
    v_add_u32 v11, v7, v5
    v_add_u32 v12, v8, v4
    v_add_u32 v13, v9, v5
    s_mul_i32 s49, s49, 320
    v_add_u32 v6, s49, v0
    s_lshl_b32 s52, s34, 12
    s_mul_i32 s53, s34, 5120
    s_lshl_b32 s55, s36, 6
    s_lshl_b32 s51, s38, 7
    s_mul_i32 s54, s38, s55
    s_mov_b32 s56, 819200
    s_mov_b32 s57, 2457600
    s_mov_b32 s10, 2621440
    s_mov_b32 s11, 0x00020000
    s_mov_b32 s15, 0x00020000
    s_waitcnt lgkmcnt(0)
    s_mov_b32 s8, s4
    s_and_b32 s9, s5, 0xffff
    s_add_u32 m0, s52, 0
    s_nop 0
    buffer_load_dwordx4 v10, s[8:11], s51 offen lds
    s_add_u32 m0, s52, 1024
    s_nop 0
    buffer_load_dwordx4 v11, s[8:11], s51 offen lds
    s_add_u32 m0, s52, 2048
    s_nop 0
    buffer_load_dwordx4 v12, s[8:11], s51 offen lds
    s_add_u32 m0, s52, 3072
    s_nop 0
    buffer_load_dwordx4 v13, s[8:11], s51 offen lds
    s_cmp_lt_u32 s46, 4
    s_cselect_b32 s6, s20, s22
    s_cselect_b32 s7, s21, s23
    s_cmp_eq_u32 s35, 3
    s_cselect_b32 s12, s6, s24
    s_cselect_b32 s13, s7, s25
    s_cselect_b32 s14, s56, s57
    s_and_b32 s13, s13, 0xffff
    v_mul_u32_u24 v7, 3277, v6
    v_lshrrev_b32 v7, 16, v7
    v_mul_u32_u24 v8, 20, v7
    v_sub_u32 v8, v6, v8
    v_mul_u32_u24 v9, 13, v8
    v_lshrrev_b32 v9, 7, v9
    v_mul_u32_u24 v1, 10, v9
    v_sub_u32 v8, v8, v1
    v_lshrrev_b32 v1, 2, v7
    v_xor_b32 v9, v9, v1
    v_and_b32 v9, 1, v9
    v_and_b32 v7, 3, v7
    v_lshl_add_u32 v7, v9, 2, v7
    v_lshl_add_u32 v7, v1, 3, v7
    v_mul_u32_u24 v7, s36, v7
    v_lshl_add_u32 v8, v8, 4, s37
    v_add_u32 v14, v7, v8
    s_add_u32 m0, s53, 65536
    s_nop 0
    buffer_load_dwordx4 v14, s[12:15], s54 offen lds
    v_add_u32 v6, 64, v6
    v_mul_u32_u24 v7, 3277, v6
    v_lshrrev_b32 v7, 16, v7
    v_mul_u32_u24 v8, 20, v7
    v_sub_u32 v8, v6, v8
    v_mul_u32_u24 v9, 13, v8
    v_lshrrev_b32 v9, 7, v9
    v_mul_u32_u24 v1, 10, v9
    v_sub_u32 v8, v8, v1
    v_lshrrev_b32 v1, 2, v7
    v_xor_b32 v9, v9, v1
    v_and_b32 v9, 1, v9
    v_and_b32 v7, 3, v7
    v_lshl_add_u32 v7, v9, 2, v7
    v_lshl_add_u32 v7, v1, 3, v7
    v_mul_u32_u24 v7, s36, v7
    v_lshl_add_u32 v8, v8, 4, s37
    v_add_u32 v15, v7, v8
    s_add_u32 m0, s53, 66560
    s_nop 0
    buffer_load_dwordx4 v15, s[12:15], s54 offen lds
    v_add_u32 v6, 64, v6
    v_mul_u32_u24 v7, 3277, v6
    v_lshrrev_b32 v7, 16, v7
    v_mul_u32_u24 v8, 20, v7
    v_sub_u32 v8, v6, v8
    v_mul_u32_u24 v9, 13, v8
    v_lshrrev_b32 v9, 7, v9
    v_mul_u32_u24 v1, 10, v9
    v_sub_u32 v8, v8, v1
    v_lshrrev_b32 v1, 2, v7
    v_xor_b32 v9, v9, v1
    v_and_b32 v9, 1, v9
    v_and_b32 v7, 3, v7
    v_lshl_add_u32 v7, v9, 2, v7
    v_lshl_add_u32 v7, v1, 3, v7
    v_mul_u32_u24 v7, s36, v7
    v_lshl_add_u32 v8, v8, 4, s37
    v_add_u32 v16, v7, v8
    s_add_u32 m0, s53, 67584
    s_nop 0
    buffer_load_dwordx4 v16, s[12:15], s54 offen lds
    v_add_u32 v6, 64, v6
    v_mul_u32_u24 v7, 3277, v6
    v_lshrrev_b32 v7, 16, v7
    v_mul_u32_u24 v8, 20, v7
    v_sub_u32 v8, v6, v8
    v_mul_u32_u24 v9, 13, v8
    v_lshrrev_b32 v9, 7, v9
    v_mul_u32_u24 v1, 10, v9
    v_sub_u32 v8, v8, v1
    v_lshrrev_b32 v1, 2, v7
    v_xor_b32 v9, v9, v1
    v_and_b32 v9, 1, v9
    v_and_b32 v7, 3, v7
    v_lshl_add_u32 v7, v9, 2, v7
    v_lshl_add_u32 v7, v1, 3, v7
    v_mul_u32_u24 v7, s36, v7
    v_lshl_add_u32 v8, v8, 4, s37
    v_add_u32 v17, v7, v8
    s_add_u32 m0, s53, 68608
    s_nop 0
    buffer_load_dwordx4 v17, s[12:15], s54 offen lds
    v_add_u32 v6, 64, v6
    v_mul_u32_u24 v7, 3277, v6
    v_lshrrev_b32 v7, 16, v7
    v_mul_u32_u24 v8, 20, v7
    v_sub_u32 v8, v6, v8
    v_mul_u32_u24 v9, 13, v8
    v_lshrrev_b32 v9, 7, v9
    v_mul_u32_u24 v1, 10, v9
    v_sub_u32 v8, v8, v1
    v_lshrrev_b32 v1, 2, v7
    v_xor_b32 v9, v9, v1
    v_and_b32 v9, 1, v9
    v_and_b32 v7, 3, v7
    v_lshl_add_u32 v7, v9, 2, v7
    v_lshl_add_u32 v7, v1, 3, v7
    v_mul_u32_u24 v7, s36, v7
    v_lshl_add_u32 v8, v8, 4, s37
    v_add_u32 v18, v7, v8
    s_add_u32 m0, s53, 69632
    s_nop 0
    buffer_load_dwordx4 v18, s[12:15], s54 offen lds
    s_add_u32 s38, s38, 1
    s_cmp_eq_u32 s38, 10
    s_cselect_b32 s38, 0, s38
    s_lshl_b32 s51, s38, 7
    s_mul_i32 s54, s38, s55
    s_lshl_b32 s48, s34, 2
    s_add_u32 s48, s48, 147456
    v_mov_b32 v20, s48
    v_and_b32 v21, 3, v0
    v_lshlrev_b32 v21, 2, v21
    v_add_u32 v21, 147472, v21
    s_barrier
    s_add_u32 m0, s52, 16384
    s_nop 0
    buffer_load_dwordx4 v10, s[8:11], s51 offen lds
    s_add_u32 m0, s52, 17408
    s_nop 0
    buffer_load_dwordx4 v11, s[8:11], s51 offen lds
    s_add_u32 m0, s52, 18432
    s_nop 0
    buffer_load_dwordx4 v12, s[8:11], s51 offen lds
    s_add_u32 m0, s52, 19456
    s_nop 0
    buffer_load_dwordx4 v13, s[8:11], s51 offen lds
    s_add_u32 m0, s53, 86016
    s_nop 0
    buffer_load_dwordx4 v14, s[12:15], s54 offen lds
    s_add_u32 m0, s53, 87040
    s_nop 0
    buffer_load_dwordx4 v15, s[12:15], s54 offen lds
    s_add_u32 m0, s53, 88064
    s_nop 0
    buffer_load_dwordx4 v16, s[12:15], s54 offen lds
    s_add_u32 m0, s53, 89088
    s_nop 0
    buffer_load_dwordx4 v17, s[12:15], s54 offen lds
    s_add_u32 m0, s53, 90112
    s_nop 0
    buffer_load_dwordx4 v18, s[12:15], s54 offen lds
    s_add_u32 s38, s38, 1
    s_cmp_eq_u32 s38, 10
    s_cselect_b32 s38, 0, s38
    s_lshl_b32 s51, s38, 7
    s_mul_i32 s54, s38, s55
    v_mov_b32 v22, 1
    s_waitcnt vmcnt(9)
    ds_write_b32 v20, v22
    s_add_u32 m0, s52, 32768
    s_nop 0
    buffer_load_dwordx4 v10, s[8:11], s51 offen lds
    s_add_u32 m0, s52, 33792
    s_nop 0
    buffer_load_dwordx4 v11, s[8:11], s51 offen lds
    s_add_u32 m0, s52, 34816
    s_nop 0
    buffer_load_dwordx4 v12, s[8:11], s51 offen lds
    s_add_u32 m0, s52, 35840
    s_nop 0
    buffer_load_dwordx4 v13, s[8:11], s51 offen lds
    s_add_u32 m0, s53, 106496
    s_nop 0
    buffer_load_dwordx4 v14, s[12:15], s54 offen lds
    s_add_u32 m0, s53, 107520
    s_nop 0
    buffer_load_dwordx4 v15, s[12:15], s54 offen lds
    s_add_u32 m0, s53, 108544
    s_nop 0
    buffer_load_dwordx4 v16, s[12:15], s54 offen lds
    s_add_u32 m0, s53, 109568
    s_nop 0
    buffer_load_dwordx4 v17, s[12:15], s54 offen lds
    s_add_u32 m0, s53, 110592
    s_nop 0
    buffer_load_dwordx4 v18, s[12:15], s54 offen lds
    s_add_u32 s38, s38, 1
    s_cmp_eq_u32 s38, 10
    s_cselect_b32 s38, 0, s38
    s_lshl_b32 s51, s38, 7
    s_mul_i32 s54, s38, s55
    v_mov_b32 v22, 2
    s_waitcnt vmcnt(9)
    ds_write_b32 v20, v22
    s_add_u32 m0, s52, 49152
    s_nop 0
    buffer_load_dwordx4 v10, s[8:11], s51 offen lds
    s_add_u32 m0, s52, 50176
    s_nop 0
    buffer_load_dwordx4 v11, s[8:11], s51 offen lds
    s_add_u32 m0, s52, 51200
    s_nop 0
    buffer_load_dwordx4 v12, s[8:11], s51 offen lds
    s_add_u32 m0, s52, 52224
    s_nop 0
    buffer_load_dwordx4 v13, s[8:11], s51 offen lds
    s_add_u32 m0, s53, 126976
    s_nop 0
    buffer_load_dwordx4 v14, s[12:15], s54 offen lds
    s_add_u32 m0, s53, 128000
    s_nop 0
    buffer_load_dwordx4 v15, s[12:15], s54 offen lds
    s_add_u32 m0, s53, 129024
    s_nop 0
    buffer_load_dwordx4 v16, s[12:15], s54 offen lds
    s_add_u32 m0, s53, 130048
    s_nop 0
    buffer_load_dwordx4 v17, s[12:15], s54 offen lds
    s_add_u32 m0, s53, 131072
    s_nop 0
    buffer_load_dwordx4 v18, s[12:15], s54 offen lds
    s_add_u32 s38, s38, 1
    s_cmp_eq_u32 s38, 10
    s_cselect_b32 s38, 0, s38
    s_lshl_b32 s51, s38, 7
    s_mul_i32 s54, s38, s55
    v_mov_b32 v22, 3
    s_waitcnt vmcnt(9)
    ds_write_b32 v20, v22
K1_LS2:
    ds_read_b32 v23, v21
    s_waitcnt lgkmcnt(0)
    v_cmp_gt_u32 vcc, 1, v23
    s_nop 1
    s_cbranch_vccz K1_LG2
    s_sleep 1
    s_branch K1_LS2
K1_LG2:
    s_add_u32 m0, s52, 0
    s_nop 0
    buffer_load_dwordx4 v10, s[8:11], s51 offen lds
    s_add_u32 m0, s52, 1024
    s_nop 0
    buffer_load_dwordx4 v11, s[8:11], s51 offen lds
    s_add_u32 m0, s52, 2048
    s_nop 0
    buffer_load_dwordx4 v12, s[8:11], s51 offen lds
    s_add_u32 m0, s52, 3072
    s_nop 0
    buffer_load_dwordx4 v13, s[8:11], s51 offen lds
    s_add_u32 m0, s53, 65536
    s_nop 0
    buffer_load_dwordx4 v14, s[12:15], s54 offen lds
    s_add_u32 m0, s53, 66560
    s_nop 0
    buffer_load_dwordx4 v15, s[12:15], s54 offen lds
    s_add_u32 m0, s53, 67584
    s_nop 0
    buffer_load_dwordx4 v16, s[12:15], s54 offen lds
    s_add_u32 m0, s53, 68608
    s_nop 0
    buffer_load_dwordx4 v17, s[12:15], s54 offen lds
    s_add_u32 m0, s53, 69632
    s_nop 0
    buffer_load_dwordx4 v18, s[12:15], s54 offen lds
    s_add_u32 s38, s38, 1
    s_cmp_eq_u32 s38, 10
    s_cselect_b32 s38, 0, s38
    s_lshl_b32 s51, s38, 7
    s_mul_i32 s54, s38, s55
    v_mov_b32 v22, 4
    s_waitcnt vmcnt(9)
    ds_write_b32 v20, v22
K1_LS3:
    ds_read_b32 v23, v21
    s_waitcnt lgkmcnt(0)
    v_cmp_gt_u32 vcc, 2, v23
    s_nop 1
    s_cbranch_vccz K1_LG3
    s_sleep 1
    s_branch K1_LS3
K1_LG3:
    s_add_u32 m0, s52, 16384
    s_nop 0
    buffer_load_dwordx4 v10, s[8:11], s51 offen lds
    s_add_u32 m0, s52, 17408
    s_nop 0
    buffer_load_dwordx4 v11, s[8:11], s51 offen lds
    s_add_u32 m0, s52, 18432
    s_nop 0
    buffer_load_dwordx4 v12, s[8:11], s51 offen lds
    s_add_u32 m0, s52, 19456
    s_nop 0
    buffer_load_dwordx4 v13, s[8:11], s51 offen lds
    s_add_u32 m0, s53, 86016
    s_nop 0
    buffer_load_dwordx4 v14, s[12:15], s54 offen lds
    s_add_u32 m0, s53, 87040
    s_nop 0
    buffer_load_dwordx4 v15, s[12:15], s54 offen lds
    s_add_u32 m0, s53, 88064
    s_nop 0
    buffer_load_dwordx4 v16, s[12:15], s54 offen lds
    s_add_u32 m0, s53, 89088
    s_nop 0
    buffer_load_dwordx4 v17, s[12:15], s54 offen lds
    s_add_u32 m0, s53, 90112
    s_nop 0
    buffer_load_dwordx4 v18, s[12:15], s54 offen lds
    s_add_u32 s38, s38, 1
    s_cmp_eq_u32 s38, 10
    s_cselect_b32 s38, 0, s38
    s_lshl_b32 s51, s38, 7
    s_mul_i32 s54, s38, s55
    v_mov_b32 v22, 5
    s_waitcnt vmcnt(9)
    ds_write_b32 v20, v22
K1_LS4:
    ds_read_b32 v23, v21
    s_waitcnt lgkmcnt(0)
    v_cmp_gt_u32 vcc, 3, v23
    s_nop 1
    s_cbranch_vccz K1_LG4
    s_sleep 1
    s_branch K1_LS4
K1_LG4:
    s_add_u32 m0, s52, 32768
    s_nop 0
    buffer_load_dwordx4 v10, s[8:11], s51 offen lds
    s_add_u32 m0, s52, 33792
    s_nop 0
    buffer_load_dwordx4 v11, s[8:11], s51 offen lds
    s_add_u32 m0, s52, 34816
    s_nop 0
    buffer_load_dwordx4 v12, s[8:11], s51 offen lds
    s_add_u32 m0, s52, 35840
    s_nop 0
    buffer_load_dwordx4 v13, s[8:11], s51 offen lds
    s_add_u32 m0, s53, 106496
    s_nop 0
    buffer_load_dwordx4 v14, s[12:15], s54 offen lds
    s_add_u32 m0, s53, 107520
    s_nop 0
    buffer_load_dwordx4 v15, s[12:15], s54 offen lds
    s_add_u32 m0, s53, 108544
    s_nop 0
    buffer_load_dwordx4 v16, s[12:15], s54 offen lds
    s_add_u32 m0, s53, 109568
    s_nop 0
    buffer_load_dwordx4 v17, s[12:15], s54 offen lds
    s_add_u32 m0, s53, 110592
    s_nop 0
    buffer_load_dwordx4 v18, s[12:15], s54 offen lds
    s_add_u32 s38, s38, 1
    s_cmp_eq_u32 s38, 10
    s_cselect_b32 s38, 0, s38
    s_lshl_b32 s51, s38, 7
    s_mul_i32 s54, s38, s55
    v_mov_b32 v22, 6
    s_waitcnt vmcnt(9)
    ds_write_b32 v20, v22
K1_LS5:
    ds_read_b32 v23, v21
    s_waitcnt lgkmcnt(0)
    v_cmp_gt_u32 vcc, 4, v23
    s_nop 1
    s_cbranch_vccz K1_LG5
    s_sleep 1
    s_branch K1_LS5
K1_LG5:
    s_add_u32 m0, s52, 49152
    s_nop 0
    buffer_load_dwordx4 v10, s[8:11], s51 offen lds
    s_add_u32 m0, s52, 50176
    s_nop 0
    buffer_load_dwordx4 v11, s[8:11], s51 offen lds
    s_add_u32 m0, s52, 51200
    s_nop 0
    buffer_load_dwordx4 v12, s[8:11], s51 offen lds
    s_add_u32 m0, s52, 52224
    s_nop 0
    buffer_load_dwordx4 v13, s[8:11], s51 offen lds
    s_add_u32 m0, s53, 126976
    s_nop 0
    buffer_load_dwordx4 v14, s[12:15], s54 offen lds
    s_add_u32 m0, s53, 128000
    s_nop 0
    buffer_load_dwordx4 v15, s[12:15], s54 offen lds
    s_add_u32 m0, s53, 129024
    s_nop 0
    buffer_load_dwordx4 v16, s[12:15], s54 offen lds
    s_add_u32 m0, s53, 130048
    s_nop 0
    buffer_load_dwordx4 v17, s[12:15], s54 offen lds
    s_add_u32 m0, s53, 131072
    s_nop 0
    buffer_load_dwordx4 v18, s[12:15], s54 offen lds
    s_add_u32 s38, s38, 1
    s_cmp_eq_u32 s38, 10
    s_cselect_b32 s38, 0, s38
    s_lshl_b32 s51, s38, 7
    s_mul_i32 s54, s38, s55
    v_mov_b32 v22, 7
    s_waitcnt vmcnt(9)
    ds_write_b32 v20, v22
K1_LS6:
    ds_read_b32 v23, v21
    s_waitcnt lgkmcnt(0)
    v_cmp_gt_u32 vcc, 5, v23
    s_nop 1
    s_cbranch_vccz K1_LG6
    s_sleep 1
    s_branch K1_LS6
K1_LG6:
    s_add_u32 m0, s52, 0
    s_nop 0
    buffer_load_dwordx4 v10, s[8:11], s51 offen lds
    s_add_u32 m0, s52, 1024
    s_nop 0
    buffer_load_dwordx4 v11, s[8:11], s51 offen lds
    s_add_u32 m0, s52, 2048
    s_nop 0
    buffer_load_dwordx4 v12, s[8:11], s51 offen lds
    s_add_u32 m0, s52, 3072
    s_nop 0
    buffer_load_dwordx4 v13, s[8:11], s51 offen lds
    s_add_u32 m0, s53, 65536
    s_nop 0
    buffer_load_dwordx4 v14, s[12:15], s54 offen lds
    s_add_u32 m0, s53, 66560
    s_nop 0
    buffer_load_dwordx4 v15, s[12:15], s54 offen lds
    s_add_u32 m0, s53, 67584
    s_nop 0
    buffer_load_dwordx4 v16, s[12:15], s54 offen lds
    s_add_u32 m0, s53, 68608
    s_nop 0
    buffer_load_dwordx4 v17, s[12:15], s54 offen lds
    s_add_u32 m0, s53, 69632
    s_nop 0
    buffer_load_dwordx4 v18, s[12:15], s54 offen lds
    s_add_u32 s38, s38, 1
    s_cmp_eq_u32 s38, 10
    s_cselect_b32 s38, 0, s38
    s_lshl_b32 s51, s38, 7
    s_mul_i32 s54, s38, s55
    v_mov_b32 v22, 8
    s_waitcnt vmcnt(9)
    ds_write_b32 v20, v22
K1_LS7:
    ds_read_b32 v23, v21
    s_waitcnt lgkmcnt(0)
    v_cmp_gt_u32 vcc, 6, v23
    s_nop 1
    s_cbranch_vccz K1_LG7
    s_sleep 1
    s_branch K1_LS7
K1_LG7:
    s_add_u32 m0, s52, 16384
    s_nop 0
    buffer_load_dwordx4 v10, s[8:11], s51 offen lds
    s_add_u32 m0, s52, 17408
    s_nop 0
    buffer_load_dwordx4 v11, s[8:11], s51 offen lds
    s_add_u32 m0, s52, 18432
    s_nop 0
    buffer_load_dwordx4 v12, s[8:11], s51 offen lds
    s_add_u32 m0, s52, 19456
    s_nop 0
    buffer_load_dwordx4 v13, s[8:11], s51 offen lds
    s_add_u32 m0, s53, 86016
    s_nop 0
    buffer_load_dwordx4 v14, s[12:15], s54 offen lds
    s_add_u32 m0, s53, 87040
    s_nop 0
    buffer_load_dwordx4 v15, s[12:15], s54 offen lds
    s_add_u32 m0, s53, 88064
    s_nop 0
    buffer_load_dwordx4 v16, s[12:15], s54 offen lds
    s_add_u32 m0, s53, 89088
    s_nop 0
    buffer_load_dwordx4 v17, s[12:15], s54 offen lds
    s_add_u32 m0, s53, 90112
    s_nop 0
    buffer_load_dwordx4 v18, s[12:15], s54 offen lds
    s_add_u32 s38, s38, 1
    s_cmp_eq_u32 s38, 10
    s_cselect_b32 s38, 0, s38
    s_lshl_b32 s51, s38, 7
    s_mul_i32 s54, s38, s55
    v_mov_b32 v22, 9
    s_waitcnt vmcnt(9)
    ds_write_b32 v20, v22
    v_mov_b32 v22, 10
    s_waitcnt vmcnt(0)
    ds_write_b32 v20, v22
    s_waitcnt lgkmcnt(0)
    s_branch K1_DONE
K1_AUX:
    s_sub_u32 s34, s34, 8
    s_movk_i32 s48, 1280
    s_load_dwordx2 s[6:7], s[0:1], 80
    v_mov_b32 v92, 163776
    v_mov_b32 v93, 0
    ds_write_b32 v92, v93
    s_waitcnt lgkmcnt(0)
    s_mov_b32 s8, s4
    s_and_b32 s9, s5, 0xffff
    s_mov_b32 s10, 2621440
    s_mov_b32 s11, 0x00020000
    s_mov_b32 s16, s30
    s_and_b32 s17, s31, 0xffff
    s_mov_b32 s18, 17825792
    s_mov_b32 s19, 0x00020000
    s_mov_b32 s12, s6
    s_and_b32 s13, s7, 0xffff
    s_mov_b32 s14, 256
    s_mov_b32 s15, 0x00020000
    s_lshl_b32 s56, s2, 2
    s_add_u32 s56, s56, s34
    s_mul_i32 s49, s56, 2560
    s_add_u32 s49, s49, 11272192
    v_lshlrev_b32 v84, 4, v0
    v_lshlrev_b32 v85, 3, v0
    v_mov_b32 v88, -1
    v_mov_b32 v89, -1
    v_mov_b32 v90, -1
    v_mov_b32 v91, -1
    v_mov_b32 v72, 0
    v_mov_b32 v73, 0
    v_mov_b32 v74, 0
    v_mov_b32 v75, 0
    s_add_u32 s60, s34, s47
    s_cmp_eq_u32 s60, 0
    s_cbranch_scc0 K1_NO_CLR
    s_lshl_b32 s60, s46, 11
    s_add_u32 s60, s60, 8691712
    s_lshl_b32 s61, s46, 10
    s_add_u32 s61, s61, 8732672
    buffer_store_dwordx4 v[72:75], v84, s[16:19], s60 offen sc1
    buffer_store_dwordx4 v[72:75], v84, s[16:19], s60 offen offset:1024 sc1
    buffer_store_dwordx4 v[72:75], v84, s[16:19], s61 offen sc1
K1_NO_CLR:
    s_barrier
    s_add_u32 s60, s34, s47
    s_cmp_eq_u32 s60, 0
    s_cbranch_scc0 K1_NO_CNT
    v_mov_b32 v76, 1
    s_lshl_b32 s60, s46, 2
    s_waitcnt vmcnt(0)
    s_mov_b64 exec, 1
    buffer_store_dword v76, v72, s[12:15], s60 offen offset:128 sc1
    s_mov_b64 exec, -1
K1_NO_CNT:
    v_mov_b32 v94, 147472
K1_PACE:
    s_sleep 4
    ds_read_b32 v95, v94
    s_waitcnt lgkmcnt(0)
    v_cmp_gt_u32 vcc, 1, v95
    s_nop 1
    s_cbranch_vccnz K1_PACE
    s_cmp_eq_u32 s34, 1
    s_cbranch_scc1 K1_AW1
    s_cmp_eq_u32 s34, 2
    s_cbranch_scc1 K1_AW2
    s_cmp_eq_u32 s34, 3
    s_cbranch_scc1 K1_AW3
K1_PACE0:
    s_sleep 8
    ds_read_b32 v95, v94
    s_waitcnt lgkmcnt(0)
    v_cmp_gt_u32 vcc, 3, v95
    s_nop 1
    s_cbranch_vccnz K1_PACE0
    s_mov_b32 s39, 0
    v_and_b32 v77, 7, v0
    v_lshlrev_b32 v77, 2, v77
K1_C0:
    buffer_load_dword v78, v77, s[12:15], 0 offen offset:128 sc1
    s_add_u32 s39, s39, 1
    s_waitcnt vmcnt(0)
    v_cmp_ne_u32 vcc, 1, v78
    s_cmp_gt_u32 s39, 0x4000
    s_cbranch_scc1 K1_C0X
    s_cbranch_vccz K1_C0X
    s_sleep 32
    s_branch K1_C0
K1_C0X:
    v_mov_b32 v95, 1
    ds_write_b32 v94, v95 offset:16
    s_waitcnt lgkmcnt(0)
    s_branch K1_DONE
K1_AW1:
    s_mov_b32 s40, s28
    s_and_b32 s41, s29, 0xffff
    s_mov_b32 s42, 1280
    s_mov_b32 s43, 0x00020000
    s_lshl_b32 s56, s2, 2
    v_lshrrev_b32 v16, 4, v0
    v_and_b32 v17, 15, v0
    v_add_u32 v18, s56, v16
    v_sub_u32 v19, 2048, v18
    v_cmp_eq_u32 vcc, 0, v18
    v_mov_b32 v20, 1024
    v_lshlrev_b32 v21, 4, v17
    v_cndmask_b32 v19, v19, v20, vcc
    v_mul_u32_u24 v22, s48, v18
    v_mul_u32_u24 v23, s48, v19
    v_add_u32 v22, v22, v21
    v_add_u32 v23, v23, v21
    buffer_load_dwordx4 v[24:27], v22, s[8:11], 0 offen offset:0
    buffer_load_dwordx4 v[44:47], v23, s[8:11], 0 offen offset:0
    buffer_load_dwordx4 v[64:67], v21, s[40:43], 0 offen offset:0
    buffer_load_dwordx4 v[28:31], v22, s[8:11], 0 offen offset:256
    buffer_load_dwordx4 v[48:51], v23, s[8:11], 0 offen offset:256
    buffer_load_dwordx4 v[68:71], v21, s[40:43], 0 offen offset:256
    buffer_load_dwordx4 v[32:35], v22, s[8:11], 0 offen offset:512
    buffer_load_dwordx4 v[52:55], v23, s[8:11], 0 offen offset:512
    buffer_load_dwordx4 v[72:75], v21, s[40:43], 0 offen offset:512
    buffer_load_dwordx4 v[36:39], v22, s[8:11], 0 offen offset:768
    buffer_load_dwordx4 v[56:59], v23, s[8:11], 0 offen offset:768
    buffer_load_dwordx4 v[76:79], v21, s[40:43], 0 offen offset:768
    buffer_load_dwordx4 v[40:43], v22, s[8:11], 0 offen offset:1024
    buffer_load_dwordx4 v[60:63], v23, s[8:11], 0 offen offset:1024
    buffer_load_dwordx4 v[80:83], v21, s[40:43], 0 offen offset:1024
    v_mov_b32 v118, 0xbf803f80
    s_waitcnt vmcnt(0)
    v_dot2_f32_bf16 v120, v24, v64, 0
    v_dot2_f32_bf16 v121, v44, v64, 0
    v_dot2_f32_bf16 v122, v24, v118, 0
    v_dot2_f32_bf16 v123, v44, v118, 0
    v_dot2_f32_bf16 v120, v25, v65, v120
    v_dot2_f32_bf16 v121, v45, v65, v121
    v_dot2_f32_bf16 v122, v25, v118, v122
    v_dot2_f32_bf16 v123, v45, v118, v123
    v_dot2_f32_bf16 v120, v26, v66, v120
    v_dot2_f32_bf16 v121, v46, v66, v121
    v_dot2_f32_bf16 v122, v26, v118, v122
    v_dot2_f32_bf16 v123, v46, v118, v123
    v_dot2_f32_bf16 v120, v27, v67, v120
    v_dot2_f32_bf16 v121, v47, v67, v121
    v_dot2_f32_bf16 v122, v27, v118, v122
    v_dot2_f32_bf16 v123, v47, v118, v123
    v_dot2_f32_bf16 v120, v28, v68, v120
    v_dot2_f32_bf16 v121, v48, v68, v121
    v_dot2_f32_bf16 v122, v28, v118, v122
    v_dot2_f32_bf16 v123, v48, v118, v123
    v_dot2_f32_bf16 v120, v29, v69, v120
    v_dot2_f32_bf16 v121, v49, v69, v121
    v_dot2_f32_bf16 v122, v29, v118, v122
    v_dot2_f32_bf16 v123, v49, v118, v123
    v_dot2_f32_bf16 v120, v30, v70, v120
    v_dot2_f32_bf16 v121, v50, v70, v121
    v_dot2_f32_bf16 v122, v30, v118, v122
    v_dot2_f32_bf16 v123, v50, v118, v123
    v_dot2_f32_bf16 v120, v31, v71, v120
    v_dot2_f32_bf16 v121, v51, v71, v121
    v_dot2_f32_bf16 v122, v31, v118, v122
    v_dot2_f32_bf16 v123, v51, v118, v123
    v_dot2_f32_bf16 v120, v32, v72, v120
    v_dot2_f32_bf16 v121, v52, v72, v121
    v_dot2_f32_bf16 v122, v32, v118, v122
    v_dot2_f32_bf16 v123, v52, v118, v123
    v_dot2_f32_bf16 v120, v33, v73, v120
    v_dot2_f32_bf16 v121, v53, v73, v121
    v_dot2_f32_bf16 v122, v33, v118, v122
    v_dot2_f32_bf16 v123, v53, v118, v123
    v_dot2_f32_bf16 v120, v34, v74, v120
    v_dot2_f32_bf16 v121, v54, v74, v121
    v_dot2_f32_bf16 v122, v34, v118, v122
    v_dot2_f32_bf16 v123, v54, v118, v123
    v_dot2_f32_bf16 v120, v35, v75, v120
    v_dot2_f32_bf16 v121, v55, v75, v121
    v_dot2_f32_bf16 v122, v35, v118, v122
    v_dot2_f32_bf16 v123, v55, v118, v123
    v_dot2_f32_bf16 v120, v36, v76, v120
    v_dot2_f32_bf16 v121, v56, v76, v121
    v_dot2_f32_bf16 v122, v36, v118, v122
    v_dot2_f32_bf16 v123, v56, v118, v123
    v_dot2_f32_bf16 v120, v37, v77, v120
    v_dot2_f32_bf16 v121, v57, v77, v121
    v_dot2_f32_bf16 v122, v37, v118, v122
    v_dot2_f32_bf16 v123, v57, v118, v123
    v_dot2_f32_bf16 v120, v38, v78, v120
    v_dot2_f32_bf16 v121, v58, v78, v121
    v_dot2_f32_bf16 v122, v38, v118, v122
    v_dot2_f32_bf16 v123, v58, v118, v123
    v_dot2_f32_bf16 v120, v39, v79, v120
    v_dot2_f32_bf16 v121, v59, v79, v121
    v_dot2_f32_bf16 v122, v39, v118, v122
    v_dot2_f32_bf16 v123, v59, v118, v123
    v_dot2_f32_bf16 v120, v40, v80, v120
    v_dot2_f32_bf16 v121, v60, v80, v121
    v_dot2_f32_bf16 v122, v40, v118, v122
    v_dot2_f32_bf16 v123, v60, v118, v123
    v_dot2_f32_bf16 v120, v41, v81, v120
    v_dot2_f32_bf16 v121, v61, v81, v121
    v_dot2_f32_bf16 v122, v41, v118, v122
    v_dot2_f32_bf16 v123, v61, v118, v123
    v_dot2_f32_bf16 v120, v42, v82, v120
    v_dot2_f32_bf16 v121, v62, v82, v121
    v_dot2_f32_bf16 v122, v42, v118, v122
    v_dot2_f32_bf16 v123, v62, v118, v123
    v_dot2_f32_bf16 v120, v43, v83, v120
    v_dot2_f32_bf16 v121, v63, v83, v121
    v_dot2_f32_bf16 v122, v43, v118, v122
    v_dot2_f32_bf16 v123, v63, v118, v123
    s_nop 3
    v_add_f32_dpp v120, v120, v120 row_ror:1 row_mask:0xf bank_mask:0xf
    v_add_f32_dpp v121, v121, v121 row_ror:1 row_mask:0xf bank_mask:0xf
    v_add_f32_dpp v122, v122, v122 row_ror:1 row_mask:0xf bank_mask:0xf
    v_add_f32_dpp v123, v123, v123 row_ror:1 row_mask:0xf bank_mask:0xf
    s_nop 1
    v_add_f32_dpp v120, v120, v120 row_ror:2 row_mask:0xf bank_mask:0xf
    v_add_f32_dpp v121, v121, v121 row_ror:2 row_mask:0xf bank_mask:0xf
    v_add_f32_dpp v122, v122, v122 row_ror:2 row_mask:0xf bank_mask:0xf
    v_add_f32_dpp v123, v123, v123 row_ror:2 row_mask:0xf bank_mask:0xf
    s_nop 1
    v_add_f32_dpp v120, v120, v120 row_ror:4 row_mask:0xf bank_mask:0xf
    v_add_f32_dpp v121, v121, v121 row_ror:4 row_mask:0xf bank_mask:0xf
    v_add_f32_dpp v122, v122, v122 row_ror:4 row_mask:0xf bank_mask:0xf
    v_add_f32_dpp v123, v123, v123 row_ror:4 row_mask:0xf bank_mask:0xf
    s_nop 1
    v_add_f32_dpp v120, v120, v120 row_ror:8 row_mask:0xf bank_mask:0xf
    v_add_f32_dpp v121, v121, v121 row_ror:8 row_mask:0xf bank_mask:0xf
    v_add_f32_dpp v122, v122, v122 row_ror:8 row_mask:0xf bank_mask:0xf
    v_add_f32_dpp v123, v123, v123 row_ror:8 row_mask:0xf bank_mask:0xf
    s_nop 1
    v_cndmask_b32 v124, v123, 0, vcc
    v_add_f32 v124, v122, v124
    v_cvt_pk_bf16_f32 v124, v124, v124
    v_cvt_pk_bf16_f32 v132, v123, 0
    v_mov_b32 v133, 0
    v_mov_b32 v134, 0
    v_mov_b32 v135, 0
    v_mov_b32 v136, 0
    v_mov_b32 v137, 0
    v_mov_b32 v138, 0
    v_mov_b32 v139, 0
    v_lshlrev_b32 v18, 2, v18
    v_lshlrev_b32 v19, 2, v19
    v_lshlrev_b32 v20, 1, v16
    s_lshr_b32 s60, s56, 6
    s_lshl_b32 s60, s60, 2
    s_bfe_u32 s61, s56, 0x20003
    s_add_u32 s60, s60, s61
    s_mul_i32 s60, s60, 11264
    s_bfe_u32 s61, s56, 0x10005
    s_lshl_b32 s61, s61, 9
    s_add_u32 s60, s60, s61
    s_and_b32 s61, s56, 7
    s_lshl_b32 s61, s61, 1
    s_add_u32 s60, s60, s61
    s_add_u32 s60, s60, 8792064
    s_mov_b32 s61, 8716288
    s_mov_b32 exec_lo, 0x00010001
    s_mov_b32 exec_hi, 0x00010001
    buffer_store_dword v120, v18, s[16:19], s61 offen sc1
    buffer_store_dword v121, v19, s[16:19], s61 offen sc1
    buffer_store_short v124, v20, s[16:19], s60 offen sc1
    s_cmp_eq_u32 s2, 0
    s_cbranch_scc0 SJ_N0
    s_mov_b64 exec, 1
    s_mov_b32 s60, 9512960
    buffer_store_dwordx4 v[132:135], v133, s[16:19], s60 offen sc1
    buffer_store_dwordx4 v[136:139], v133, s[16:19], s60 offen offset:512 sc1
SJ_N0:
    s_mov_b64 exec, -1
    s_branch K1_AUXEND
K1_AW2:
    s_mov_b32 s40, s26
    s_and_b32 s41, s27, 0xffff
    s_mov_b32 s42, 819200
    s_mov_b32 s43, 0x00020000
    s_cmp_lt_u32 s2, 200
    s_cbranch_scc0 SJ_END
    v_lshrrev_b32 v16, 4, v0
    v_and_b32 v17, 15, v0
    s_mul_i32 s60, s2, 13108
    s_lshr_b32 s60, s60, 16
    s_mul_i32 s61, s60, 5
    s_sub_u32 s61, s2, s61
    s_cmp_lt_u32 s61, 4
    s_cbranch_scc0 SJ_HI
    s_mul_i32 s62, s61, 160
    v_lshrrev_b32 v116, 1, v16
    v_mul_u32_u24 v116, 20, v116
    v_and_b32 v117, 1, v16
    v_lshl_add_u32 v116, v117, 2, v116
    v_add_u32 v116, s62, v116
    s_movk_i32 s63, 10240
    s_mov_b32 s59, 51200
    s_branch SJ_GO
SJ_HI:
    v_mul_u32_u24 v116, 40, v16
    v_add_u32 v116, 16, v116
    s_movk_i32 s63, 25600
    s_mov_b32 s59, 204800
SJ_GO:
    v_mul_u32_u24 v116, s48, v116
    s_lshl_b32 s60, s60, 5
    v_lshl_add_u32 v116, v17, 1, v116
    v_add_u32 v116, s60, v116
    v_add_u32 v117, s63, v116
    s_mov_b32 s58, 0
    buffer_load_ushort v24, v116, s[40:43], s58 offen offset:0
    buffer_load_ushort v40, v116, s[40:43], s58 offen offset:1280
    buffer_load_ushort v25, v116, s[40:43], s58 offen offset:2560
    buffer_load_ushort v41, v116, s[40:43], s58 offen offset:3840
    buffer_load_ushort v26, v117, s[40:43], s58 offen offset:0
    buffer_load_ushort v42, v117, s[40:43], s58 offen offset:1280
    buffer_load_ushort v27, v117, s[40:43], s58 offen offset:2560
    buffer_load_ushort v43, v117, s[40:43], s58 offen offset:3840
    s_add_u32 s58, s58, s59
    buffer_load_ushort v28, v116, s[40:43], s58 offen offset:0
    buffer_load_ushort v44, v116, s[40:43], s58 offen offset:1280
    buffer_load_ushort v29, v116, s[40:43], s58 offen offset:2560
    buffer_load_ushort v45, v116, s[40:43], s58 offen offset:3840
    buffer_load_ushort v30, v117, s[40:43], s58 offen offset:0
    buffer_load_ushort v46, v117, s[40:43], s58 offen offset:1280
    buffer_load_ushort v31, v117, s[40:43], s58 offen offset:2560
    buffer_load_ushort v47, v117, s[40:43], s58 offen offset:3840
    s_add_u32 s58, s58, s59
    buffer_load_ushort v32, v116, s[40:43], s58 offen offset:0
    buffer_load_ushort v48, v116, s[40:43], s58 offen offset:1280
    buffer_load_ushort v33, v116, s[40:43], s58 offen offset:2560
    buffer_load_ushort v49, v116, s[40:43], s58 offen offset:3840
    buffer_load_ushort v34, v117, s[40:43], s58 offen offset:0
    buffer_load_ushort v50, v117, s[40:43], s58 offen offset:1280
    buffer_load_ushort v35, v117, s[40:43], s58 offen offset:2560
    buffer_load_ushort v51, v117, s[40:43], s58 offen offset:3840
    s_add_u32 s58, s58, s59
    buffer_load_ushort v36, v116, s[40:43], s58 offen offset:0
    buffer_load_ushort v52, v116, s[40:43], s58 offen offset:1280
    buffer_load_ushort v37, v116, s[40:43], s58 offen offset:2560
    buffer_load_ushort v53, v116, s[40:43], s58 offen offset:3840
    buffer_load_ushort v38, v117, s[40:43], s58 offen offset:0
    buffer_load_ushort v54, v117, s[40:43], s58 offen offset:1280
    buffer_load_ushort v39, v117, s[40:43], s58 offen offset:2560
    buffer_load_ushort v55, v117, s[40:43], s58 offen offset:3840
    s_add_u32 s58, s58, s59
    s_lshl_b32 s60, s2, 12
    s_add_u32 s60, s60, 10354688
    s_waitcnt vmcnt(0)
    v_lshl_or_b32 v24, v40, 16, v24
    v_lshl_or_b32 v25, v41, 16, v25
    v_lshl_or_b32 v26, v42, 16, v26
    v_lshl_or_b32 v27, v43, 16, v27
    buffer_store_dwordx4 v[24:27], v84, s[16:19], s60 offen offset:0 sc1
    v_lshl_or_b32 v28, v44, 16, v28
    v_lshl_or_b32 v29, v45, 16, v29
    v_lshl_or_b32 v30, v46, 16, v30
    v_lshl_or_b32 v31, v47, 16, v31
    buffer_store_dwordx4 v[28:31], v84, s[16:19], s60 offen offset:1024 sc1
    v_lshl_or_b32 v32, v48, 16, v32
    v_lshl_or_b32 v33, v49, 16, v33
    v_lshl_or_b32 v34, v50, 16, v34
    v_lshl_or_b32 v35, v51, 16, v35
    buffer_store_dwordx4 v[32:35], v84, s[16:19], s60 offen offset:2048 sc1
    v_lshl_or_b32 v36, v52, 16, v36
    v_lshl_or_b32 v37, v53, 16, v37
    v_lshl_or_b32 v38, v54, 16, v38
    v_lshl_or_b32 v39, v55, 16, v39
    buffer_store_dwordx4 v[36:39], v84, s[16:19], s60 offen offset:3072 sc1
SJ_END:
    s_branch K1_AUXEND
K1_AW3:
    s_mul_i32 s49, s2, 10240
    s_add_u32 s49, s49, 11272192
    buffer_store_dwordx4 v[88:91], v84, s[16:19], s49 offen offset:0 sc1
    buffer_store_dwordx4 v[88:91], v84, s[16:19], s49 offen offset:1024 sc1
    buffer_store_dwordx4 v[88:91], v84, s[16:19], s49 offen offset:2048 sc1
    buffer_store_dwordx4 v[88:91], v84, s[16:19], s49 offen offset:3072 sc1
    s_add_u32 s49, s49, 4096
    buffer_store_dwordx4 v[88:91], v84, s[16:19], s49 offen offset:0 sc1
    buffer_store_dwordx4 v[88:91], v84, s[16:19], s49 offen offset:1024 sc1
    buffer_store_dwordx4 v[88:91], v84, s[16:19], s49 offen offset:2048 sc1
    buffer_store_dwordx4 v[88:91], v84, s[16:19], s49 offen offset:3072 sc1
    s_add_u32 s49, s49, 4096
    buffer_store_dwordx4 v[88:91], v84, s[16:19], s49 offen offset:0 sc1
    buffer_store_dwordx4 v[88:91], v84, s[16:19], s49 offen offset:1024 sc1
K1_AUXEND:
    s_waitcnt vmcnt(0)
K1_AXW:
    ds_read_b32 v95, v94 offset:16
    s_waitcnt lgkmcnt(0)
    v_cmp_eq_u32 vcc, 1, v95
    s_nop 1
    s_cbranch_vccnz K1_AXG
    s_sleep 4
    s_branch K1_AXW
K1_AXG:
    v_mov_b32 v128, 163776
    v_mov_b32 v129, 1
    s_mov_b64 exec, 1
    ds_add_rtn_u32 v130, v128, v129
    s_waitcnt lgkmcnt(0)
    v_cmp_eq_u32 vcc, s71, v130
    s_lshl_b32 s72, s2, 2
    s_add_u32 s72, s72, 8732672
    s_cbranch_vccz XSIG_A
    s_mov_b64 exec, 0xff
    v_and_b32 v128, 63, v0
    v_lshlrev_b32 v128, 10, v128
    v_mov_b32 v129, 1
    buffer_store_dword v129, v128, s[16:19], s72 offen sc1
XSIG_A:
    s_mov_b64 exec, -1
    s_branch K1_DONE
K1_COMPUTE:
    s_and_b32 s36, s34, 1
    s_lshr_b32 s37, s34, 1
    v_and_b32 v3, 15, v0
    v_lshlrev_b32 v3, 2, v3
    v_add_u32 v3, 147456, v3
    v_mov_b32 v4, 0
    ds_write_b32 v3, v4
    s_waitcnt lgkmcnt(0)
    s_barrier
    s_mov_b32 s16, s30
    s_and_b32 s17, s31, 0xffff
    s_mov_b32 s18, 17825792
    s_mov_b32 s19, 0x00020000
    s_cmp_eq_u32 s33, 1
    s_cbranch_scc1 K1_VF
    v_and_b32 v1, 15, v0
    v_lshrrev_b32 v2, 4, v0
    v_bfe_u32 v3, v1, 1, 3
    v_xor_b32 v3, v3, v2
    s_lshl_b32 s48, s36, 13
    v_lshlrev_b32 v16, 7, v1
    v_add_u32 v16, s48, v16
    v_lshl_add_u32 v4, v3, 4, v16
    v_xor_b32 v5, 64, v4
    v_lshrrev_b32 v17, 2, v1
    v_and_b32 v18, 3, v1
    v_mul_u32_u24 v19, 1280, v2
    v_mul_u32_u24 v17, 320, v17
    s_mul_i32 s48, s37, 10240
    s_add_u32 s48, s48, 0x10000
    v_add3_u32 v19, v19, v17, s48
    v_and_b32 v20, 1, v2
    v_mul_u32_u24 v20, 160, v20
    v_sub_u32 v21, 160, v20
    v_lshrrev_b32 v22, 1, v18
    v_mul_u32_u24 v22, 40, v22
    v_and_b32 v23, 1, v18
    v_lshl_add_u32 v22, v23, 4, v22
    v_add_u32 v22, v22, v19
    v_add_u32 v6, v22, v20
    v_add_u32 v7, v22, v21
    v_mul_u32_u24 v22, 40, v18
    v_add3_u32 v22, v22, v19, 32
    v_add_u32 v8, v22, v20
    v_add_u32 v9, v22, v21
    v_mov_b32 v10, v4
    v_mov_b32 v11, v5
    v_mov_b32 v12, v6
    v_mov_b32 v13, v7
    v_mov_b32 v14, v8
    v_mov_b32 v15, v9
    v_mov_b32 v16, 0
    v_mov_b32 v17, 0
    v_mov_b32 v18, 0
    v_mov_b32 v19, 0
    v_mov_b32 v20, 0
    v_mov_b32 v21, 0
    v_mov_b32 v22, 0
    v_mov_b32 v23, 0
    v_mov_b32 v24, 0
    v_mov_b32 v25, 0
    v_mov_b32 v26, 0
    v_mov_b32 v27, 0
    v_mov_b32 v28, 0
    v_mov_b32 v29, 0
    v_mov_b32 v30, 0
    v_mov_b32 v31, 0
    v_mov_b32 v32, 0
    v_mov_b32 v33, 0
    v_mov_b32 v34, 0
    v_mov_b32 v35, 0
    v_mov_b32 v36, 0
    v_mov_b32 v37, 0
    v_mov_b32 v38, 0
    v_mov_b32 v39, 0
    v_mov_b32 v40, 0
    v_mov_b32 v41, 0
    v_mov_b32 v42, 0
    v_mov_b32 v43, 0
    v_mov_b32 v44, 0
    v_mov_b32 v45, 0
    v_mov_b32 v46, 0
    v_mov_b32 v47, 0
    v_mov_b32 v48, 0
    v_mov_b32 v49, 0
    v_mov_b32 v50, 0
    v_mov_b32 v51, 0
    v_mov_b32 v52, 0
    v_mov_b32 v53, 0
    v_mov_b32 v54, 0
    v_mov_b32 v55, 0
    v_mov_b32 v56, 0
    v_mov_b32 v57, 0
    v_mov_b32 v58, 0
    v_mov_b32 v59, 0
    v_mov_b32 v60, 0
    v_mov_b32 v61, 0
    v_mov_b32 v62, 0
    v_mov_b32 v63, 0
    v_mov_b32 v64, 0
    v_mov_b32 v65, 0
    v_mov_b32 v66, 0
    v_mov_b32 v67, 0
    v_mov_b32 v68, 0
    v_mov_b32 v69, 0
    v_mov_b32 v70, 0
    v_mov_b32 v71, 0
    v_mov_b32 v72, 0
    v_mov_b32 v73, 0
    v_mov_b32 v74, 0
    v_mov_b32 v75, 0
    v_mov_b32 v76, 0
    v_mov_b32 v77, 0
    v_mov_b32 v78, 0
    v_mov_b32 v79, 0
    v_mov_b32 v80, 0
    v_mov_b32 v81, 0
    v_mov_b32 v82, 0
    v_mov_b32 v83, 0
    v_mov_b32 v84, 0
    v_mov_b32 v85, 0
    v_mov_b32 v86, 0
    v_mov_b32 v87, 0
    v_mov_b32 v88, 0
    v_mov_b32 v89, 0
    v_mov_b32 v90, 0
    v_mov_b32 v91, 0
    v_mov_b32 v92, 0
    v_mov_b32 v93, 0
    v_mov_b32 v94, 0
    v_mov_b32 v95, 0
    v_mov_b32 v132, 0
    v_mov_b32 v133, 0
    v_mov_b32 v134, 0
    v_mov_b32 v135, 0
    v_mov_b32 v136, 0
    v_mov_b32 v137, 0
    v_mov_b32 v138, 0
    v_mov_b32 v139, 0
    v_mov_b32 v140, 0
    v_mov_b32 v141, 0
    v_mov_b32 v142, 0
    v_mov_b32 v143, 0
    v_mov_b32 v144, 0
    v_mov_b32 v145, 0
    v_mov_b32 v146, 0
    v_mov_b32 v147, 0
    v_mov_b32 v148, 0
    v_mov_b32 v149, 0
    v_mov_b32 v150, 0
    v_mov_b32 v151, 0
    v_mov_b32 v152, 0
    v_mov_b32 v153, 0
    v_mov_b32 v154, 0
    v_mov_b32 v155, 0
    v_mov_b32 v156, 0
    v_mov_b32 v157, 0
    v_mov_b32 v158, 0
    v_mov_b32 v159, 0
    v_mov_b32 v160, 0
    v_mov_b32 v161, 0
    v_mov_b32 v162, 0
    v_mov_b32 v163, 0
    v_mov_b32 v164, 0
    v_mov_b32 v165, 0
    v_mov_b32 v166, 0
    v_mov_b32 v167, 0
    s_mov_b32 s60, 0
    v_and_b32 v3, 3, v0
    v_lshlrev_b32 v3, 2, v3
    v_add_u32 v3, 147456, v3
    s_lshl_b32 s48, s34, 2
    s_add_u32 s48, s48, 147472
    v_mov_b32 v0, s48
    s_branch P1_LOOP0_S
P1_LOOP0:
    s_waitcnt lgkmcnt(0)
    v_cmp_ge_u32 vcc, s60, v1
    v_mov_b32 v2, s60
    s_nop 0
    s_cbranch_vccz P1_LOOP0_B
P1_LOOP0_S:
    ds_read_b32 v1, v3
    s_waitcnt lgkmcnt(0)
    v_cmp_ge_u32 vcc, s60, v1
    v_mov_b32 v2, s60
    s_nop 0
    s_cbranch_vccz P1_LOOP0_B
    s_sleep 1
    s_branch P1_LOOP0_S
P1_LOOP0_B:
    ds_write_b32 v0, v2
    v_mfma_f32_16x16x32_bf16 v[16:19], v[148:151], v[132:135], v[16:19]
    ds_read_b128 v[96:99], v10 offset:0
    ds_read_b128 v[100:103], v10 offset:2048
    v_mfma_f32_16x16x32_bf16 v[20:23], v[148:151], v[136:139], v[20:23]
    ds_read_b128 v[104:107], v11 offset:4096
    ds_read_b128 v[108:111], v11 offset:6144
    v_mfma_f32_16x16x32_bf16 v[24:27], v[148:151], v[140:143], v[24:27]
    ds_read_b64_tr_b16 v[112:113], v12 offset:0
    ds_read_b64_tr_b16 v[114:115], v13 offset:0
    v_mfma_f32_16x16x32_bf16 v[28:31], v[148:151], v[144:147], v[28:31]
    ds_read_b64_tr_b16 v[116:117], v12 offset:8
    ds_read_b64_tr_b16 v[118:119], v13 offset:8
    v_mfma_f32_16x16x32_bf16 v[32:35], v[152:155], v[132:135], v[32:35]
    ds_read_b64_tr_b16 v[120:121], v12 offset:80
    ds_read_b64_tr_b16 v[122:123], v13 offset:80
    v_mfma_f32_16x16x32_bf16 v[36:39], v[152:155], v[136:139], v[36:39]
    ds_read_b64_tr_b16 v[124:125], v12 offset:88
    ds_read_b64_tr_b16 v[126:127], v13 offset:88
    v_mfma_f32_16x16x32_bf16 v[40:43], v[152:155], v[140:143], v[40:43]
    ds_read_b64_tr_b16 v[128:129], v14 offset:0
    ds_read_b64_tr_b16 v[130:131], v15 offset:0
    v_mfma_f32_16x16x32_bf16 v[44:47], v[152:155], v[144:147], v[44:47]
    s_add_u32 s60, s60, 1
    v_mfma_f32_16x16x32_bf16 v[48:51], v[156:159], v[132:135], v[48:51]
    s_and_b32 s61, s60, 3
    v_mfma_f32_16x16x32_bf16 v[52:55], v[156:159], v[136:139], v[52:55]
    s_lshl_b32 s62, s61, 14
    v_mfma_f32_16x16x32_bf16 v[56:59], v[156:159], v[140:143], v[56:59]
    s_mul_i32 s63, s61, 20480
    v_mfma_f32_16x16x32_bf16 v[60:63], v[156:159], v[144:147], v[60:63]
    v_mfma_f32_16x16x32_bf16 v[64:67], v[160:163], v[132:135], v[64:67]
    v_mfma_f32_16x16x32_bf16 v[68:71], v[160:163], v[136:139], v[68:71]
    v_mfma_f32_16x16x32_bf16 v[72:75], v[160:163], v[140:143], v[72:75]
    v_mfma_f32_16x16x32_bf16 v[76:79], v[160:163], v[144:147], v[76:79]
    v_mfma_f32_16x16x32_bf16 v[80:83], v[164:167], v[132:135], v[80:83]
    v_mfma_f32_16x16x32_bf16 v[84:87], v[164:167], v[136:139], v[84:87]
    v_mfma_f32_16x16x32_bf16 v[88:91], v[164:167], v[140:143], v[88:91]
    v_mfma_f32_16x16x32_bf16 v[92:95], v[164:167], v[144:147], v[92:95]
    s_waitcnt lgkmcnt(0)
    v_mfma_f32_16x16x32_bf16 v[16:19], v[112:115], v[96:99], v[16:19]
    ds_read_b128 v[132:135], v11 offset:0
    ds_read_b128 v[136:139], v11 offset:2048
    v_mfma_f32_16x16x32_bf16 v[20:23], v[112:115], v[100:103], v[20:23]
    ds_read_b128 v[140:143], v10 offset:4096
    ds_read_b128 v[144:147], v10 offset:6144
    v_mfma_f32_16x16x32_bf16 v[24:27], v[112:115], v[104:107], v[24:27]
    ds_read_b64_tr_b16 v[148:149], v12 offset:5120
    ds_read_b64_tr_b16 v[150:151], v13 offset:5120
    v_mfma_f32_16x16x32_bf16 v[28:31], v[112:115], v[108:111], v[28:31]
    ds_read_b64_tr_b16 v[152:153], v12 offset:5128
    ds_read_b64_tr_b16 v[154:155], v13 offset:5128
    v_mfma_f32_16x16x32_bf16 v[32:35], v[116:119], v[96:99], v[32:35]
    ds_read_b64_tr_b16 v[156:157], v12 offset:5200
    ds_read_b64_tr_b16 v[158:159], v13 offset:5200
    v_mfma_f32_16x16x32_bf16 v[36:39], v[116:119], v[100:103], v[36:39]
    ds_read_b64_tr_b16 v[160:161], v12 offset:5208
    ds_read_b64_tr_b16 v[162:163], v13 offset:5208
    v_mfma_f32_16x16x32_bf16 v[40:43], v[116:119], v[104:107], v[40:43]
    ds_read_b64_tr_b16 v[164:165], v14 offset:5120
    ds_read_b64_tr_b16 v[166:167], v15 offset:5120
    v_mfma_f32_16x16x32_bf16 v[44:47], v[116:119], v[108:111], v[44:47]
    v_add_u32 v10, s62, v4
    v_mfma_f32_16x16x32_bf16 v[48:51], v[120:123], v[96:99], v[48:51]
    v_add_u32 v11, s62, v5
    v_mfma_f32_16x16x32_bf16 v[52:55], v[120:123], v[100:103], v[52:55]
    v_add_u32 v12, s63, v6
    v_mfma_f32_16x16x32_bf16 v[56:59], v[120:123], v[104:107], v[56:59]
    v_add_u32 v13, s63, v7
    v_mfma_f32_16x16x32_bf16 v[60:63], v[120:123], v[108:111], v[60:63]
    v_add_u32 v14, s63, v8
    v_mfma_f32_16x16x32_bf16 v[64:67], v[124:127], v[96:99], v[64:67]
    v_add_u32 v15, s63, v9
    v_mfma_f32_16x16x32_bf16 v[68:71], v[124:127], v[100:103], v[68:71]
    s_cmp_lt_u32 s60, 10
    v_mfma_f32_16x16x32_bf16 v[72:75], v[124:127], v[104:107], v[72:75]
    s_nop 0
    v_mfma_f32_16x16x32_bf16 v[76:79], v[124:127], v[108:111], v[76:79]
    s_nop 0
    v_mfma_f32_16x16x32_bf16 v[80:83], v[128:131], v[96:99], v[80:83]
    ds_read_b32 v1, v3
    v_mfma_f32_16x16x32_bf16 v[84:87], v[128:131], v[100:103], v[84:87]
    v_mfma_f32_16x16x32_bf16 v[88:91], v[128:131], v[104:107], v[88:91]
    v_mfma_f32_16x16x32_bf16 v[92:95], v[128:131], v[108:111], v[92:95]
    s_cbranch_scc1 P1_LOOP0
    v_mbcnt_lo_u32_b32 v0, -1, 0
    v_mbcnt_hi_u32_b32 v0, -1, v0
    s_waitcnt lgkmcnt(0)
    v_and_b32 v1, 15, v0
    v_lshrrev_b32 v2, 4, v0
    s_waitcnt lgkmcnt(0)
    v_mfma_f32_16x16x32_bf16 v[16:19], v[148:151], v[132:135], v[16:19]
    v_mfma_f32_16x16x32_bf16 v[20:23], v[148:151], v[136:139], v[20:23]
    v_mfma_f32_16x16x32_bf16 v[24:27], v[148:151], v[140:143], v[24:27]
    v_mfma_f32_16x16x32_bf16 v[28:31], v[148:151], v[144:147], v[28:31]
    v_mfma_f32_16x16x32_bf16 v[32:35], v[152:155], v[132:135], v[32:35]
    v_mfma_f32_16x16x32_bf16 v[36:39], v[152:155], v[136:139], v[36:39]
    v_mfma_f32_16x16x32_bf16 v[40:43], v[152:155], v[140:143], v[40:43]
    v_mfma_f32_16x16x32_bf16 v[44:47], v[152:155], v[144:147], v[44:47]
    v_mfma_f32_16x16x32_bf16 v[48:51], v[156:159], v[132:135], v[48:51]
    v_mfma_f32_16x16x32_bf16 v[52:55], v[156:159], v[136:139], v[52:55]
    v_mfma_f32_16x16x32_bf16 v[56:59], v[156:159], v[140:143], v[56:59]
    v_mfma_f32_16x16x32_bf16 v[60:63], v[156:159], v[144:147], v[60:63]
    v_mfma_f32_16x16x32_bf16 v[64:67], v[160:163], v[132:135], v[64:67]
    v_mfma_f32_16x16x32_bf16 v[68:71], v[160:163], v[136:139], v[68:71]
    v_mfma_f32_16x16x32_bf16 v[72:75], v[160:163], v[140:143], v[72:75]
    v_mfma_f32_16x16x32_bf16 v[76:79], v[160:163], v[144:147], v[76:79]
    v_mfma_f32_16x16x32_bf16 v[80:83], v[164:167], v[132:135], v[80:83]
    v_mfma_f32_16x16x32_bf16 v[84:87], v[164:167], v[136:139], v[84:87]
    v_mfma_f32_16x16x32_bf16 v[88:91], v[164:167], v[140:143], v[88:91]
    v_mfma_f32_16x16x32_bf16 v[92:95], v[164:167], v[144:147], v[92:95]
    s_lshl_b32 s48, s32, 2
    s_lshl_b32 s49, s36, 1
    s_add_u32 s48, s48, s49
    s_mov_b32 s50, 81920
    s_mov_b32 s51, 172032
    s_mul_i32 s52, s48, 1280
    s_add_u32 s52, s52, 0
    s_add_u32 s53, s48, 62
    s_and_b32 s53, s53, 63
    s_mul_i32 s53, s53, 2688
    s_add_u32 s53, s53, 3145728
    s_movk_i32 s54, 1024
    s_movk_i32 s55, 2688
    s_cmp_eq_u32 s37, 0
    s_cselect_b32 s56, s50, s51
    s_cselect_b32 s57, s52, s53
    s_cselect_b32 s58, s54, s55
    s_lshl_b32 s59, s46, 2
    s_mul_i32 s59, s59, s56
    s_add_u32 s57, s57, s59
    s_add_u32 s58, s58, s57
    s_lshl_b32 s59, s56, 1
    s_add_u32 s60, s57, s59
    s_add_u32 s61, s58, s59
    s_mov_b32 s62, 0x3ea52b5c
    s_mov_b32 s63, s62
    v_lshrrev_b32 v3, 1, v2
    v_mul_u32_u24 v3, s56, v3
    v_and_b32 v4, 1, v2
    v_lshl_add_u32 v3, v4, 9, v3
    v_lshl_add_u32 v3, v1, 4, v3
    v_mul_u32_u24 v4, s56, v2
    v_lshl_add_u32 v5, v1, 4, v4
    v_lshl_add_u32 v4, v1, 3, v4
    s_cmp_eq_u32 s37, 0
    s_cbranch_scc0 K1_NOSCALE
    v_pk_mul_f32 v[16:17], v[16:17], s[62:63]
    v_pk_mul_f32 v[18:19], v[18:19], s[62:63]
    v_pk_mul_f32 v[32:33], v[32:33], s[62:63]
    v_pk_mul_f32 v[34:35], v[34:35], s[62:63]
    v_cvt_pk_bf16_f32 v96, v16, v17
    v_cvt_pk_bf16_f32 v97, v18, v19
    v_cvt_pk_bf16_f32 v98, v32, v33
    v_cvt_pk_bf16_f32 v99, v34, v35
    buffer_store_dwordx4 v[96:99], v3, s[16:19], s57 offen offset:0
    v_pk_mul_f32 v[20:21], v[20:21], s[62:63]
    v_pk_mul_f32 v[22:23], v[22:23], s[62:63]
    v_pk_mul_f32 v[36:37], v[36:37], s[62:63]
    v_pk_mul_f32 v[38:39], v[38:39], s[62:63]
    v_cvt_pk_bf16_f32 v100, v20, v21
    v_cvt_pk_bf16_f32 v101, v22, v23
    v_cvt_pk_bf16_f32 v102, v36, v37
    v_cvt_pk_bf16_f32 v103, v38, v39
    buffer_store_dwordx4 v[100:103], v3, s[16:19], s57 offen offset:256
    v_pk_mul_f32 v[24:25], v[24:25], s[62:63]
    v_pk_mul_f32 v[26:27], v[26:27], s[62:63]
    v_pk_mul_f32 v[40:41], v[40:41], s[62:63]
    v_pk_mul_f32 v[42:43], v[42:43], s[62:63]
    v_cvt_pk_bf16_f32 v104, v24, v25
    v_cvt_pk_bf16_f32 v105, v26, v27
    v_cvt_pk_bf16_f32 v106, v40, v41
    v_cvt_pk_bf16_f32 v107, v42, v43
    buffer_store_dwordx4 v[104:107], v3, s[16:19], s58 offen offset:0
    v_pk_mul_f32 v[28:29], v[28:29], s[62:63]
    v_pk_mul_f32 v[30:31], v[30:31], s[62:63]
    v_pk_mul_f32 v[44:45], v[44:45], s[62:63]
    v_pk_mul_f32 v[46:47], v[46:47], s[62:63]
    v_cvt_pk_bf16_f32 v108, v28, v29
    v_cvt_pk_bf16_f32 v109, v30, v31
    v_cvt_pk_bf16_f32 v110, v44, v45
    v_cvt_pk_bf16_f32 v111, v46, v47
    buffer_store_dwordx4 v[108:111], v3, s[16:19], s58 offen offset:256
    v_pk_mul_f32 v[48:49], v[48:49], s[62:63]
    v_pk_mul_f32 v[50:51], v[50:51], s[62:63]
    v_pk_mul_f32 v[64:65], v[64:65], s[62:63]
    v_pk_mul_f32 v[66:67], v[66:67], s[62:63]
    v_cvt_pk_bf16_f32 v112, v48, v49
    v_cvt_pk_bf16_f32 v113, v50, v51
    v_cvt_pk_bf16_f32 v114, v64, v65
    v_cvt_pk_bf16_f32 v115, v66, v67
    buffer_store_dwordx4 v[112:115], v3, s[16:19], s60 offen offset:0
    v_pk_mul_f32 v[52:53], v[52:53], s[62:63]
    v_pk_mul_f32 v[54:55], v[54:55], s[62:63]
    v_pk_mul_f32 v[68:69], v[68:69], s[62:63]
    v_pk_mul_f32 v[70:71], v[70:71], s[62:63]
    v_cvt_pk_bf16_f32 v116, v52, v53
    v_cvt_pk_bf16_f32 v117, v54, v55
    v_cvt_pk_bf16_f32 v118, v68, v69
    v_cvt_pk_bf16_f32 v119, v70, v71
    buffer_store_dwordx4 v[116:119], v3, s[16:19], s60 offen offset:256
    v_pk_mul_f32 v[56:57], v[56:57], s[62:63]
    v_pk_mul_f32 v[58:59], v[58:59], s[62:63]
    v_pk_mul_f32 v[72:73], v[72:73], s[62:63]
    v_pk_mul_f32 v[74:75], v[74:75], s[62:63]
    v_cvt_pk_bf16_f32 v120, v56, v57
    v_cvt_pk_bf16_f32 v121, v58, v59
    v_cvt_pk_bf16_f32 v122, v72, v73
    v_cvt_pk_bf16_f32 v123, v74, v75
    buffer_store_dwordx4 v[120:123], v3, s[16:19], s61 offen offset:0
    v_pk_mul_f32 v[60:61], v[60:61], s[62:63]
    v_pk_mul_f32 v[62:63], v[62:63], s[62:63]
    v_pk_mul_f32 v[76:77], v[76:77], s[62:63]
    v_pk_mul_f32 v[78:79], v[78:79], s[62:63]
    v_cvt_pk_bf16_f32 v124, v60, v61
    v_cvt_pk_bf16_f32 v125, v62, v63
    v_cvt_pk_bf16_f32 v126, v76, v77
    v_cvt_pk_bf16_f32 v127, v78, v79
    buffer_store_dwordx4 v[124:127], v3, s[16:19], s61 offen offset:256
    v_pk_mul_f32 v[80:81], v[80:81], s[62:63]
    v_pk_mul_f32 v[82:83], v[82:83], s[62:63]
    v_pk_mul_f32 v[88:89], v[88:89], s[62:63]
    v_pk_mul_f32 v[90:91], v[90:91], s[62:63]
    v_cvt_pk_bf16_f32 v128, v80, v81
    v_cvt_pk_bf16_f32 v129, v82, v83
    v_cvt_pk_bf16_f32 v130, v88, v89
    v_cvt_pk_bf16_f32 v131, v90, v91
    buffer_store_dwordx4 v[128:131], v5, s[16:19], s57 offen offset:2048
    v_pk_mul_f32 v[84:85], v[84:85], s[62:63]
    v_pk_mul_f32 v[86:87], v[86:87], s[62:63]
    v_pk_mul_f32 v[92:93], v[92:93], s[62:63]
    v_pk_mul_f32 v[94:95], v[94:95], s[62:63]
    v_cvt_pk_bf16_f32 v132, v84, v85
    v_cvt_pk_bf16_f32 v133, v86, v87
    v_cvt_pk_bf16_f32 v134, v92, v93
    v_cvt_pk_bf16_f32 v135, v94, v95
    buffer_store_dwordx4 v[132:135], v5, s[16:19], s57 offen offset:2304
    s_branch K1_END
K1_NOSCALE:
    v_cvt_pk_bf16_f32 v96, v16, v17
    v_cvt_pk_bf16_f32 v97, v18, v19
    v_cvt_pk_bf16_f32 v98, v32, v33
    v_cvt_pk_bf16_f32 v99, v34, v35
    buffer_store_dwordx4 v[96:99], v3, s[16:19], s57 offen offset:0
    v_cvt_pk_bf16_f32 v100, v20, v21
    v_cvt_pk_bf16_f32 v101, v22, v23
    v_cvt_pk_bf16_f32 v102, v36, v37
    v_cvt_pk_bf16_f32 v103, v38, v39
    buffer_store_dwordx4 v[100:103], v3, s[16:19], s57 offen offset:256
    v_cvt_pk_bf16_f32 v104, v24, v25
    v_cvt_pk_bf16_f32 v105, v26, v27
    v_cvt_pk_bf16_f32 v106, v40, v41
    v_cvt_pk_bf16_f32 v107, v42, v43
    buffer_store_dwordx4 v[104:107], v3, s[16:19], s58 offen offset:0
    v_cvt_pk_bf16_f32 v108, v28, v29
    v_cvt_pk_bf16_f32 v109, v30, v31
    v_cvt_pk_bf16_f32 v110, v44, v45
    v_cvt_pk_bf16_f32 v111, v46, v47
    buffer_store_dwordx4 v[108:111], v3, s[16:19], s58 offen offset:256
    v_cvt_pk_bf16_f32 v112, v48, v49
    v_cvt_pk_bf16_f32 v113, v50, v51
    v_cvt_pk_bf16_f32 v114, v64, v65
    v_cvt_pk_bf16_f32 v115, v66, v67
    buffer_store_dwordx4 v[112:115], v3, s[16:19], s60 offen offset:0
    v_cvt_pk_bf16_f32 v116, v52, v53
    v_cvt_pk_bf16_f32 v117, v54, v55
    v_cvt_pk_bf16_f32 v118, v68, v69
    v_cvt_pk_bf16_f32 v119, v70, v71
    buffer_store_dwordx4 v[116:119], v3, s[16:19], s60 offen offset:256
    v_cvt_pk_bf16_f32 v120, v56, v57
    v_cvt_pk_bf16_f32 v121, v58, v59
    v_cvt_pk_bf16_f32 v122, v72, v73
    v_cvt_pk_bf16_f32 v123, v74, v75
    buffer_store_dwordx4 v[120:123], v3, s[16:19], s61 offen offset:0
    v_cvt_pk_bf16_f32 v124, v60, v61
    v_cvt_pk_bf16_f32 v125, v62, v63
    v_cvt_pk_bf16_f32 v126, v76, v77
    v_cvt_pk_bf16_f32 v127, v78, v79
    buffer_store_dwordx4 v[124:127], v3, s[16:19], s61 offen offset:256
    v_cvt_pk_bf16_f32 v128, v80, v81
    v_cvt_pk_bf16_f32 v129, v82, v83
    buffer_store_dwordx2 v[128:129], v4, s[16:19], s57 offen offset:1024
    v_cvt_pk_bf16_f32 v130, v84, v85
    v_cvt_pk_bf16_f32 v131, v86, v87
    buffer_store_dwordx2 v[130:131], v4, s[16:19], s57 offen offset:1152
    v_cvt_pk_bf16_f32 v132, v88, v89
    v_cvt_pk_bf16_f32 v133, v90, v91
    buffer_store_dwordx2 v[132:133], v4, s[16:19], s58 offen offset:1024
    v_cvt_pk_bf16_f32 v134, v92, v93
    v_cvt_pk_bf16_f32 v135, v94, v95
    buffer_store_dwordx2 v[134:135], v4, s[16:19], s58 offen offset:1152
    v_dot2_f32_bf16 v16, v96, v96, 0
    v_dot2_f32_bf16 v17, v100, v100, 0
    v_dot2_f32_bf16 v18, v104, v104, 0
    v_dot2_f32_bf16 v19, v108, v108, 0
    v_dot2_f32_bf16 v20, v112, v112, 0
    v_dot2_f32_bf16 v21, v116, v116, 0
    v_dot2_f32_bf16 v22, v120, v120, 0
    v_dot2_f32_bf16 v23, v124, v124, 0
    v_dot2_f32_bf16 v16, v97, v97, v16
    v_dot2_f32_bf16 v17, v101, v101, v17
    v_dot2_f32_bf16 v18, v105, v105, v18
    v_dot2_f32_bf16 v19, v109, v109, v19
    v_dot2_f32_bf16 v20, v113, v113, v20
    v_dot2_f32_bf16 v21, v117, v117, v21
    v_dot2_f32_bf16 v22, v121, v121, v22
    v_dot2_f32_bf16 v23, v125, v125, v23
    v_dot2_f32_bf16 v16, v98, v98, v16
    v_dot2_f32_bf16 v17, v102, v102, v17
    v_dot2_f32_bf16 v18, v106, v106, v18
    v_dot2_f32_bf16 v19, v110, v110, v19
    v_dot2_f32_bf16 v20, v114, v114, v20
    v_dot2_f32_bf16 v21, v118, v118, v21
    v_dot2_f32_bf16 v22, v122, v122, v22
    v_dot2_f32_bf16 v23, v126, v126, v23
    v_dot2_f32_bf16 v16, v99, v99, v16
    v_dot2_f32_bf16 v17, v103, v103, v17
    v_dot2_f32_bf16 v18, v107, v107, v18
    v_dot2_f32_bf16 v19, v111, v111, v19
    v_dot2_f32_bf16 v20, v115, v115, v20
    v_dot2_f32_bf16 v21, v119, v119, v21
    v_dot2_f32_bf16 v22, v123, v123, v22
    v_dot2_f32_bf16 v23, v127, v127, v23
    v_dot2_f32_bf16 v24, v128, v128, 0
    v_dot2_f32_bf16 v25, v130, v130, 0
    v_dot2_f32_bf16 v26, v132, v132, 0
    v_dot2_f32_bf16 v27, v134, v134, 0
    v_dot2_f32_bf16 v24, v129, v129, v24
    v_dot2_f32_bf16 v25, v131, v131, v25
    v_dot2_f32_bf16 v26, v133, v133, v26
    v_dot2_f32_bf16 v27, v135, v135, v27
    s_lshl_b32 s50, s46, 5
    s_lshl_b32 s51, s32, 1
    s_add_u32 s50, s50, s51
    s_add_u32 s50, s50, s36
    s_lshl_b32 s50, s50, 7
    s_add_u32 s50, s50, 8650752
    v_lshlrev_b32 v7, 1, v0
    v_mov_b32 v8, 0
    buffer_store_short v8, v7, s[16:19], s50 offen
    v_max3_f32 v16, v16, v17, v18
    v_max3_f32 v20, v20, v21, v22
    v_max3_f32 v24, v24, v25, v26
    v_max_f32 v16, v16, v19
    v_max_f32 v20, v20, v23
    v_max_f32 v24, v24, v27
    s_nop 0
    v_max_f32_dpp v16, v16, v16 row_ror:1 row_mask:0xf bank_mask:0xf
    v_max_f32_dpp v20, v20, v20 row_ror:1 row_mask:0xf bank_mask:0xf
    v_max_f32_dpp v24, v24, v24 row_ror:1 row_mask:0xf bank_mask:0xf
    s_nop 0
    v_max_f32_dpp v16, v16, v16 row_ror:2 row_mask:0xf bank_mask:0xf
    v_max_f32_dpp v20, v20, v20 row_ror:2 row_mask:0xf bank_mask:0xf
    v_max_f32_dpp v24, v24, v24 row_ror:2 row_mask:0xf bank_mask:0xf
    s_nop 0
    v_max_f32_dpp v16, v16, v16 row_ror:4 row_mask:0xf bank_mask:0xf
    v_max_f32_dpp v20, v20, v20 row_ror:4 row_mask:0xf bank_mask:0xf
    v_max_f32_dpp v24, v24, v24 row_ror:4 row_mask:0xf bank_mask:0xf
    s_nop 0
    v_max_f32_dpp v16, v16, v16 row_ror:8 row_mask:0xf bank_mask:0xf
    v_max_f32_dpp v20, v20, v20 row_ror:8 row_mask:0xf bank_mask:0xf
    v_max_f32_dpp v24, v24, v24 row_ror:8 row_mask:0xf bank_mask:0xf
    v_lshrrev_b32 v5, 1, v2
    v_lshlrev_b32 v5, 4, v5
    v_and_b32 v6, 1, v2
    v_lshl_add_u32 v5, v6, 2, v5
    v_lshlrev_b32 v6, 4, v2
    v_cmp_eq_u32 vcc, 0, v1
    s_and_saveexec_b64 s[64:65], vcc
    buffer_store_dword v16, v5, s[16:19], s50 offen
    buffer_store_dword v20, v5, s[16:19], s50 offen offset:32
    buffer_store_dword v24, v6, s[16:19], s50 offen offset:8
    s_branch K1_END
K1_VF:
    v_and_b32 v1, 15, v0
    v_lshrrev_b32 v2, 4, v0
    v_bfe_u32 v3, v1, 1, 3
    v_xor_b32 v3, v3, v2
    s_lshl_b32 s48, s36, 13
    v_lshrrev_b32 v17, 3, v1
    v_and_b32 v16, 7, v1
    v_lshl_add_u32 v16, v17, 5, v16
    v_lshlrev_b32 v16, 7, v16
    v_add_u32 v16, s48, v16
    v_lshl_add_u32 v4, v3, 4, v16
    v_xor_b32 v5, 64, v4
    v_lshrrev_b32 v17, 2, v1
    v_and_b32 v18, 3, v1
    v_mul_u32_u24 v19, 1280, v2
    v_mul_u32_u24 v17, 320, v17
    s_mul_i32 s48, s37, 10240
    s_add_u32 s48, s48, 0x10000
    v_add3_u32 v19, v19, v17, s48
    v_and_b32 v20, 1, v2
    v_mul_u32_u24 v20, 160, v20
    v_sub_u32 v21, 160, v20
    v_lshl_add_u32 v19, v18, 3, v19
    v_add_u32 v6, v19, v20
    v_add_u32 v7, v19, v21
    v_mov_b32 v8, v6
    v_mov_b32 v9, v6
    v_mov_b32 v10, v4
    v_mov_b32 v11, v5
    v_mov_b32 v12, v6
    v_mov_b32 v13, v7
    v_mov_b32 v14, v8
    v_mov_b32 v15, v9
    v_mov_b32 v16, 0
    v_mov_b32 v17, 0
    v_mov_b32 v18, 0
    v_mov_b32 v19, 0
    v_mov_b32 v20, 0
    v_mov_b32 v21, 0
    v_mov_b32 v22, 0
    v_mov_b32 v23, 0
    v_mov_b32 v24, 0
    v_mov_b32 v25, 0
    v_mov_b32 v26, 0
    v_mov_b32 v27, 0
    v_mov_b32 v28, 0
    v_mov_b32 v29, 0
    v_mov_b32 v30, 0
    v_mov_b32 v31, 0
    v_mov_b32 v32, 0
    v_mov_b32 v33, 0
    v_mov_b32 v34, 0
    v_mov_b32 v35, 0
    v_mov_b32 v36, 0
    v_mov_b32 v37, 0
    v_mov_b32 v38, 0
    v_mov_b32 v39, 0
    v_mov_b32 v40, 0
    v_mov_b32 v41, 0
    v_mov_b32 v42, 0
    v_mov_b32 v43, 0
    v_mov_b32 v44, 0
    v_mov_b32 v45, 0
    v_mov_b32 v46, 0
    v_mov_b32 v47, 0
    v_mov_b32 v48, 0
    v_mov_b32 v49, 0
    v_mov_b32 v50, 0
    v_mov_b32 v51, 0
    v_mov_b32 v52, 0
    v_mov_b32 v53, 0
    v_mov_b32 v54, 0
    v_mov_b32 v55, 0
    v_mov_b32 v56, 0
    v_mov_b32 v57, 0
    v_mov_b32 v58, 0
    v_mov_b32 v59, 0
    v_mov_b32 v60, 0
    v_mov_b32 v61, 0
    v_mov_b32 v62, 0
    v_mov_b32 v63, 0
    v_mov_b32 v64, 0
    v_mov_b32 v65, 0
    v_mov_b32 v66, 0
    v_mov_b32 v67, 0
    v_mov_b32 v68, 0
    v_mov_b32 v69, 0
    v_mov_b32 v70, 0
    v_mov_b32 v71, 0
    v_mov_b32 v72, 0
    v_mov_b32 v73, 0
    v_mov_b32 v74, 0
    v_mov_b32 v75, 0
    v_mov_b32 v76, 0
    v_mov_b32 v77, 0
    v_mov_b32 v78, 0
    v_mov_b32 v79, 0
    v_mov_b32 v80, 0
    v_mov_b32 v81, 0
    v_mov_b32 v82, 0
    v_mov_b32 v83, 0
    v_mov_b32 v84, 0
    v_mov_b32 v85, 0
    v_mov_b32 v86, 0
    v_mov_b32 v87, 0
    v_mov_b32 v88, 0
    v_mov_b32 v89, 0
    v_mov_b32 v90, 0
    v_mov_b32 v91, 0
    v_mov_b32 v92, 0
    v_mov_b32 v93, 0
    v_mov_b32 v94, 0
    v_mov_b32 v95, 0
    v_mov_b32 v132, 0
    v_mov_b32 v133, 0
    v_mov_b32 v134, 0
    v_mov_b32 v135, 0
    v_mov_b32 v136, 0
    v_mov_b32 v137, 0
    v_mov_b32 v138, 0
    v_mov_b32 v139, 0
    v_mov_b32 v140, 0
    v_mov_b32 v141, 0
    v_mov_b32 v142, 0
    v_mov_b32 v143, 0
    v_mov_b32 v144, 0
    v_mov_b32 v145, 0
    v_mov_b32 v146, 0
    v_mov_b32 v147, 0
    v_mov_b32 v148, 0
    v_mov_b32 v149, 0
    v_mov_b32 v150, 0
    v_mov_b32 v151, 0
    v_mov_b32 v152, 0
    v_mov_b32 v153, 0
    v_mov_b32 v154, 0
    v_mov_b32 v155, 0
    v_mov_b32 v156, 0
    v_mov_b32 v157, 0
    v_mov_b32 v158, 0
    v_mov_b32 v159, 0
    v_mov_b32 v160, 0
    v_mov_b32 v161, 0
    v_mov_b32 v162, 0
    v_mov_b32 v163, 0
    v_mov_b32 v164, 0
    v_mov_b32 v165, 0
    v_mov_b32 v166, 0
    v_mov_b32 v167, 0
    s_mov_b32 s60, 0
    v_and_b32 v3, 3, v0
    v_lshlrev_b32 v3, 2, v3
    v_add_u32 v3, 147456, v3
    s_lshl_b32 s48, s34, 2
    s_add_u32 s48, s48, 147472
    v_mov_b32 v0, s48
    s_branch P1_LOOP1_S
P1_LOOP1:
    s_waitcnt lgkmcnt(0)
    v_cmp_ge_u32 vcc, s60, v1
    v_mov_b32 v2, s60
    s_nop 0
    s_cbranch_vccz P1_LOOP1_B
P1_LOOP1_S:
    ds_read_b32 v1, v3
    s_waitcnt lgkmcnt(0)
    v_cmp_ge_u32 vcc, s60, v1
    v_mov_b32 v2, s60
    s_nop 0
    s_cbranch_vccz P1_LOOP1_B
    s_sleep 1
    s_branch P1_LOOP1_S
P1_LOOP1_B:
    ds_write_b32 v0, v2
    v_mfma_f32_16x16x32_bf16 v[16:19], v[132:135], v[148:151], v[16:19]
    ds_read_b128 v[96:99], v10 offset:0
    ds_read_b128 v[100:103], v11 offset:1024
    v_mfma_f32_16x16x32_bf16 v[20:23], v[136:139], v[148:151], v[20:23]
    ds_read_b128 v[104:107], v10 offset:2048
    ds_read_b128 v[108:111], v11 offset:3072
    v_mfma_f32_16x16x32_bf16 v[24:27], v[140:143], v[148:151], v[24:27]
    ds_read_b64_tr_b16 v[112:113], v12 offset:0
    ds_read_b64_tr_b16 v[114:115], v13 offset:0
    v_mfma_f32_16x16x32_bf16 v[28:31], v[144:147], v[148:151], v[28:31]
    ds_read_b64_tr_b16 v[116:117], v12 offset:32
    ds_read_b64_tr_b16 v[118:119], v13 offset:32
    v_mfma_f32_16x16x32_bf16 v[32:35], v[132:135], v[152:155], v[32:35]
    ds_read_b64_tr_b16 v[120:121], v12 offset:64
    ds_read_b64_tr_b16 v[122:123], v13 offset:64
    v_mfma_f32_16x16x32_bf16 v[36:39], v[136:139], v[152:155], v[36:39]
    ds_read_b64_tr_b16 v[124:125], v12 offset:96
    ds_read_b64_tr_b16 v[126:127], v13 offset:96
    v_mfma_f32_16x16x32_bf16 v[40:43], v[140:143], v[152:155], v[40:43]
    ds_read_b64_tr_b16 v[128:129], v12 offset:128
    ds_read_b64_tr_b16 v[130:131], v13 offset:128
    v_mfma_f32_16x16x32_bf16 v[44:47], v[144:147], v[152:155], v[44:47]
    s_add_u32 s60, s60, 1
    v_mfma_f32_16x16x32_bf16 v[48:51], v[132:135], v[156:159], v[48:51]
    s_and_b32 s61, s60, 3
    v_mfma_f32_16x16x32_bf16 v[52:55], v[136:139], v[156:159], v[52:55]
    s_lshl_b32 s62, s61, 14
    v_mfma_f32_16x16x32_bf16 v[56:59], v[140:143], v[156:159], v[56:59]
    s_mul_i32 s63, s61, 20480
    v_mfma_f32_16x16x32_bf16 v[60:63], v[144:147], v[156:159], v[60:63]
    v_mfma_f32_16x16x32_bf16 v[64:67], v[132:135], v[160:163], v[64:67]
    v_mfma_f32_16x16x32_bf16 v[68:71], v[136:139], v[160:163], v[68:71]
    v_mfma_f32_16x16x32_bf16 v[72:75], v[140:143], v[160:163], v[72:75]
    v_mfma_f32_16x16x32_bf16 v[76:79], v[144:147], v[160:163], v[76:79]
    v_mfma_f32_16x16x32_bf16 v[80:83], v[132:135], v[164:167], v[80:83]
    v_mfma_f32_16x16x32_bf16 v[84:87], v[136:139], v[164:167], v[84:87]
    v_mfma_f32_16x16x32_bf16 v[88:91], v[140:143], v[164:167], v[88:91]
    v_mfma_f32_16x16x32_bf16 v[92:95], v[144:147], v[164:167], v[92:95]
    s_waitcnt lgkmcnt(0)
    v_mfma_f32_16x16x32_bf16 v[16:19], v[96:99], v[112:115], v[16:19]
    ds_read_b128 v[132:135], v11 offset:0
    ds_read_b128 v[136:139], v10 offset:1024
    v_mfma_f32_16x16x32_bf16 v[20:23], v[100:103], v[112:115], v[20:23]
    ds_read_b128 v[140:143], v11 offset:2048
    ds_read_b128 v[144:147], v10 offset:3072
    v_mfma_f32_16x16x32_bf16 v[24:27], v[104:107], v[112:115], v[24:27]
    ds_read_b64_tr_b16 v[148:149], v12 offset:5120
    ds_read_b64_tr_b16 v[150:151], v13 offset:5120
    v_mfma_f32_16x16x32_bf16 v[28:31], v[108:111], v[112:115], v[28:31]
    ds_read_b64_tr_b16 v[152:153], v12 offset:5152
    ds_read_b64_tr_b16 v[154:155], v13 offset:5152
    v_mfma_f32_16x16x32_bf16 v[32:35], v[96:99], v[116:119], v[32:35]
    ds_read_b64_tr_b16 v[156:157], v12 offset:5184
    ds_read_b64_tr_b16 v[158:159], v13 offset:5184
    v_mfma_f32_16x16x32_bf16 v[36:39], v[100:103], v[116:119], v[36:39]
    ds_read_b64_tr_b16 v[160:161], v12 offset:5216
    ds_read_b64_tr_b16 v[162:163], v13 offset:5216
    v_mfma_f32_16x16x32_bf16 v[40:43], v[104:107], v[116:119], v[40:43]
    ds_read_b64_tr_b16 v[164:165], v12 offset:5248
    ds_read_b64_tr_b16 v[166:167], v13 offset:5248
    v_mfma_f32_16x16x32_bf16 v[44:47], v[108:111], v[116:119], v[44:47]
    v_add_u32 v10, s62, v4
    v_mfma_f32_16x16x32_bf16 v[48:51], v[96:99], v[120:123], v[48:51]
    v_add_u32 v11, s62, v5
    v_mfma_f32_16x16x32_bf16 v[52:55], v[100:103], v[120:123], v[52:55]
    v_add_u32 v12, s63, v6
    v_mfma_f32_16x16x32_bf16 v[56:59], v[104:107], v[120:123], v[56:59]
    v_add_u32 v13, s63, v7
    v_mfma_f32_16x16x32_bf16 v[60:63], v[108:111], v[120:123], v[60:63]
    v_add_u32 v14, s63, v8
    v_mfma_f32_16x16x32_bf16 v[64:67], v[96:99], v[124:127], v[64:67]
    v_add_u32 v15, s63, v9
    v_mfma_f32_16x16x32_bf16 v[68:71], v[100:103], v[124:127], v[68:71]
    s_cmp_lt_u32 s60, 10
    v_mfma_f32_16x16x32_bf16 v[72:75], v[104:107], v[124:127], v[72:75]
    s_nop 0
    v_mfma_f32_16x16x32_bf16 v[76:79], v[108:111], v[124:127], v[76:79]
    s_nop 0
    v_mfma_f32_16x16x32_bf16 v[80:83], v[96:99], v[128:131], v[80:83]
    ds_read_b32 v1, v3
    v_mfma_f32_16x16x32_bf16 v[84:87], v[100:103], v[128:131], v[84:87]
    v_mfma_f32_16x16x32_bf16 v[88:91], v[104:107], v[128:131], v[88:91]
    v_mfma_f32_16x16x32_bf16 v[92:95], v[108:111], v[128:131], v[92:95]
    s_cbranch_scc1 P1_LOOP1
    v_mbcnt_lo_u32_b32 v0, -1, 0
    v_mbcnt_hi_u32_b32 v0, -1, v0
    s_waitcnt lgkmcnt(0)
    v_and_b32 v1, 15, v0
    v_lshrrev_b32 v2, 4, v0
    s_waitcnt lgkmcnt(0)
    v_mfma_f32_16x16x32_bf16 v[16:19], v[132:135], v[148:151], v[16:19]
    v_mfma_f32_16x16x32_bf16 v[20:23], v[136:139], v[148:151], v[20:23]
    v_mfma_f32_16x16x32_bf16 v[24:27], v[140:143], v[148:151], v[24:27]
    v_mfma_f32_16x16x32_bf16 v[28:31], v[144:147], v[148:151], v[28:31]
    v_mfma_f32_16x16x32_bf16 v[32:35], v[132:135], v[152:155], v[32:35]
    v_mfma_f32_16x16x32_bf16 v[36:39], v[136:139], v[152:155], v[36:39]
    v_mfma_f32_16x16x32_bf16 v[40:43], v[140:143], v[152:155], v[40:43]
    v_mfma_f32_16x16x32_bf16 v[44:47], v[144:147], v[152:155], v[44:47]
    v_mfma_f32_16x16x32_bf16 v[48:51], v[132:135], v[156:159], v[48:51]
    v_mfma_f32_16x16x32_bf16 v[52:55], v[136:139], v[156:159], v[52:55]
    v_mfma_f32_16x16x32_bf16 v[56:59], v[140:143], v[156:159], v[56:59]
    v_mfma_f32_16x16x32_bf16 v[60:63], v[144:147], v[156:159], v[60:63]
    v_mfma_f32_16x16x32_bf16 v[64:67], v[132:135], v[160:163], v[64:67]
    v_mfma_f32_16x16x32_bf16 v[68:71], v[136:139], v[160:163], v[68:71]
    v_mfma_f32_16x16x32_bf16 v[72:75], v[140:143], v[160:163], v[72:75]
    v_mfma_f32_16x16x32_bf16 v[76:79], v[144:147], v[160:163], v[76:79]
    v_mfma_f32_16x16x32_bf16 v[80:83], v[132:135], v[164:167], v[80:83]
    v_mfma_f32_16x16x32_bf16 v[84:87], v[136:139], v[164:167], v[84:87]
    v_mfma_f32_16x16x32_bf16 v[88:91], v[140:143], v[164:167], v[88:91]
    v_mfma_f32_16x16x32_bf16 v[92:95], v[144:147], v[164:167], v[92:95]
    s_lshl_b32 s48, s32, 2
    s_lshl_b32 s49, s36, 1
    s_add_u32 s48, s48, s49
    v_lshrrev_b32 v3, 1, v2
    v_and_b32 v4, 1, v2
    s_cmp_eq_u32 s37, 1
    s_cbranch_scc1 K1_F
    s_mul_i32 s49, s46, 688128
    s_mul_i32 s50, s48, 2688
    s_add_u32 s60, s49, s50
    s_add_u32 s60, s60, 3147008
    s_mov_b32 s51, 172032
    v_mul_u32_u24 v3, 2688, v3
    v_mul_u32_u24 v4, 336, v4
    v_add_u32 v3, v3, v4
    v_add_u32 v4, 0, v1
    v_mul_u32_u24 v5, 3277, v4
    v_lshrrev_b32 v5, 16, v5
    v_mul_u32_u24 v6, 20, v5
    v_sub_u32 v6, v4, v6
    v_mul_u32_u24 v5, s51, v5
    v_lshl_add_u32 v6, v6, 4, v3
    v_add_u32 v8, v5, v6
    v_cvt_pk_bf16_f32 v96, v16, v17
    v_cvt_pk_bf16_f32 v97, v18, v19
    v_cvt_pk_bf16_f32 v98, v20, v21
    v_cvt_pk_bf16_f32 v99, v22, v23
    buffer_store_dwordx4 v[96:99], v8, s[16:19], s60 offen offset:0
    v_cvt_pk_bf16_f32 v100, v24, v25
    v_cvt_pk_bf16_f32 v101, v26, v27
    v_cvt_pk_bf16_f32 v102, v28, v29
    v_cvt_pk_bf16_f32 v103, v30, v31
    buffer_store_dwordx4 v[100:103], v8, s[16:19], s60 offen offset:672
    v_add_u32 v4, 16, v1
    v_mul_u32_u24 v5, 3277, v4
    v_lshrrev_b32 v5, 16, v5
    v_mul_u32_u24 v6, 20, v5
    v_sub_u32 v6, v4, v6
    v_mul_u32_u24 v5, s51, v5
    v_lshl_add_u32 v6, v6, 4, v3
    v_add_u32 v9, v5, v6
    v_cvt_pk_bf16_f32 v104, v32, v33
    v_cvt_pk_bf16_f32 v105, v34, v35
    v_cvt_pk_bf16_f32 v106, v36, v37
    v_cvt_pk_bf16_f32 v107, v38, v39
    buffer_store_dwordx4 v[104:107], v9, s[16:19], s60 offen offset:0
    v_cvt_pk_bf16_f32 v108, v40, v41
    v_cvt_pk_bf16_f32 v109, v42, v43
    v_cvt_pk_bf16_f32 v110, v44, v45
    v_cvt_pk_bf16_f32 v111, v46, v47
    buffer_store_dwordx4 v[108:111], v9, s[16:19], s60 offen offset:672
    v_add_u32 v4, 32, v1
    v_mul_u32_u24 v5, 3277, v4
    v_lshrrev_b32 v5, 16, v5
    v_mul_u32_u24 v6, 20, v5
    v_sub_u32 v6, v4, v6
    v_mul_u32_u24 v5, s51, v5
    v_lshl_add_u32 v6, v6, 4, v3
    v_add_u32 v10, v5, v6
    v_cvt_pk_bf16_f32 v112, v48, v49
    v_cvt_pk_bf16_f32 v113, v50, v51
    v_cvt_pk_bf16_f32 v114, v52, v53
    v_cvt_pk_bf16_f32 v115, v54, v55
    buffer_store_dwordx4 v[112:115], v10, s[16:19], s60 offen offset:0
    v_cvt_pk_bf16_f32 v116, v56, v57
    v_cvt_pk_bf16_f32 v117, v58, v59
    v_cvt_pk_bf16_f32 v118, v60, v61
    v_cvt_pk_bf16_f32 v119, v62, v63
    buffer_store_dwordx4 v[116:119], v10, s[16:19], s60 offen offset:672
    v_add_u32 v4, 48, v1
    v_mul_u32_u24 v5, 3277, v4
    v_lshrrev_b32 v5, 16, v5
    v_mul_u32_u24 v6, 20, v5
    v_sub_u32 v6, v4, v6
    v_mul_u32_u24 v5, s51, v5
    v_lshl_add_u32 v6, v6, 4, v3
    v_add_u32 v11, v5, v6
    v_cvt_pk_bf16_f32 v120, v64, v65
    v_cvt_pk_bf16_f32 v121, v66, v67
    v_cvt_pk_bf16_f32 v122, v68, v69
    v_cvt_pk_bf16_f32 v123, v70, v71
    buffer_store_dwordx4 v[120:123], v11, s[16:19], s60 offen offset:0
    v_cvt_pk_bf16_f32 v124, v72, v73
    v_cvt_pk_bf16_f32 v125, v74, v75
    v_cvt_pk_bf16_f32 v126, v76, v77
    v_cvt_pk_bf16_f32 v127, v78, v79
    buffer_store_dwordx4 v[124:127], v11, s[16:19], s60 offen offset:672
    v_add_u32 v4, 64, v1
    v_mul_u32_u24 v5, 3277, v4
    v_lshrrev_b32 v5, 16, v5
    v_mul_u32_u24 v6, 20, v5
    v_sub_u32 v6, v4, v6
    v_mul_u32_u24 v5, s51, v5
    v_lshl_add_u32 v6, v6, 4, v3
    v_add_u32 v12, v5, v6
    v_cvt_pk_bf16_f32 v128, v80, v81
    v_cvt_pk_bf16_f32 v129, v82, v83
    v_cvt_pk_bf16_f32 v130, v84, v85
    v_cvt_pk_bf16_f32 v131, v86, v87
    buffer_store_dwordx4 v[128:131], v12, s[16:19], s60 offen offset:0
    v_cvt_pk_bf16_f32 v132, v88, v89
    v_cvt_pk_bf16_f32 v133, v90, v91
    v_cvt_pk_bf16_f32 v134, v92, v93
    v_cvt_pk_bf16_f32 v135, v94, v95
    buffer_store_dwordx4 v[132:135], v12, s[16:19], s60 offen offset:672
    v_bfe_u32 v4, v0, 3, 2
    v_mul_u32_u24 v4, s51, v4
    v_bfe_u32 v5, v0, 2, 1
    v_mul_u32_u24 v5, 2688, v5
    v_and_b32 v6, 3, v0
    v_mul_u32_u24 v7, 336, v6
    v_lshlrev_b32 v6, 4, v6
    v_add_u32 v6, 1024, v6
    v_cmp_gt_u32 vcc, 32, v0
    v_mov_b32 v20, 0x3f803f80
    s_nop 0
    v_cndmask_b32 v6, v6, v7, vcc
    v_cndmask_b32 v16, 0, v20, vcc
    v_add3_u32 v4, v4, v5, v6
    v_mov_b32 v17, v16
    v_mov_b32 v18, v16
    v_mov_b32 v19, v16
    buffer_store_dwordx4 v[16:19], v4, s[16:19], s60 offen offset:320
    s_branch K1_END
K1_F:
    s_mov_b32 s50, 8781824
    s_mov_b32 s51, 9568256
    s_mov_b32 s52, 1.0
    s_mov_b32 s53, -1.0
    s_cmp_lt_u32 s46, 4
    s_cselect_b32 s54, s50, s51
    s_cselect_b32 s55, s52, s53
    s_and_b32 s49, s46, 3
    s_mul_i32 s49, s49, 5
    s_mul_i32 s60, s48, 11264
    s_add_u32 s60, s60, s54
    v_lshlrev_b32 v5, 9, v4
    v_lshl_add_u32 v5, v1, 4, v5
    v_mul_u32_u24 v3, 11264, v3
    v_add_u32 v3, v3, v5
    s_add_u32 s50, s49, 0
    s_lshr_b32 s51, s50, 1
    s_lshl_b32 s51, s51, 10
    s_and_b32 s50, s50, 1
    s_lshl_b32 s50, s50, 8
    s_add_u32 s64, s50, s51
    s_add_u32 s50, s49, 1
    s_lshr_b32 s51, s50, 1
    s_lshl_b32 s51, s51, 10
    s_and_b32 s50, s50, 1
    s_lshl_b32 s50, s50, 8
    s_add_u32 s65, s50, s51
    s_add_u32 s50, s49, 2
    s_lshr_b32 s51, s50, 1
    s_lshl_b32 s51, s51, 10
    s_and_b32 s50, s50, 1
    s_lshl_b32 s50, s50, 8
    s_add_u32 s66, s50, s51
    s_add_u32 s50, s49, 3
    s_lshr_b32 s51, s50, 1
    s_lshl_b32 s51, s51, 10
    s_and_b32 s50, s50, 1
    s_lshl_b32 s50, s50, 8
    s_add_u32 s67, s50, s51
    s_add_u32 s50, s49, 4
    s_lshr_b32 s51, s50, 1
    s_lshl_b32 s51, s51, 10
    s_and_b32 s50, s50, 1
    s_lshl_b32 s50, s50, 8
    s_add_u32 s68, s50, s51
    s_cmp_lg_u32 s48, 0
    s_cbranch_scc1 K1_F_NOSPECIAL
    s_add_u32 s61, s54, 720896
    v_cmp_gt_u32 vcc, 16, v0
    v_mov_b32 v133, 0
    v_mov_b32 v134, 0
    v_mov_b32 v135, 0
    v_cndmask_b32 v8, 0, v24, vcc
    v_cvt_pk_bf16_f32 v132, v8, 0
    v_cndmask_b32 v24, v24, v133, vcc
    s_add_u32 s62, s61, s64
    s_mov_b32 exec_hi, 0
    buffer_store_dwordx4 v[132:135], v5, s[16:19], s62 offen sc1
    s_mov_b32 exec_hi, -1
    s_nop 1
    v_cndmask_b32 v8, 0, v40, vcc
    v_cvt_pk_bf16_f32 v132, v8, 0
    v_cndmask_b32 v40, v40, v133, vcc
    s_add_u32 s62, s61, s65
    s_mov_b32 exec_hi, 0
    buffer_store_dwordx4 v[132:135], v5, s[16:19], s62 offen sc1
    s_mov_b32 exec_hi, -1
    s_nop 1
    v_cndmask_b32 v8, 0, v56, vcc
    v_cvt_pk_bf16_f32 v132, v8, 0
    v_cndmask_b32 v56, v56, v133, vcc
    s_add_u32 s62, s61, s66
    s_mov_b32 exec_hi, 0
    buffer_store_dwordx4 v[132:135], v5, s[16:19], s62 offen sc1
    s_mov_b32 exec_hi, -1
    s_nop 1
    v_cndmask_b32 v8, 0, v72, vcc
    v_cvt_pk_bf16_f32 v132, v8, 0
    v_cndmask_b32 v72, v72, v133, vcc
    s_add_u32 s62, s61, s67
    s_mov_b32 exec_hi, 0
    buffer_store_dwordx4 v[132:135], v5, s[16:19], s62 offen sc1
    s_mov_b32 exec_hi, -1
    s_nop 1
    v_cndmask_b32 v8, 0, v88, vcc
    v_cvt_pk_bf16_f32 v132, v8, 0
    v_cndmask_b32 v88, v88, v133, vcc
    s_add_u32 s62, s61, s68
    s_mov_b32 exec_hi, 0
    buffer_store_dwordx4 v[132:135], v5, s[16:19], s62 offen sc1
    s_mov_b32 exec_hi, -1
    s_nop 1
K1_F_NOSPECIAL:
    v_fma_f32 v16, v24, s55, v16
    v_fma_f32 v17, v25, s55, v17
    v_fma_f32 v18, v26, s55, v18
    v_fma_f32 v19, v27, s55, v19
    v_fma_f32 v20, v28, s55, v20
    v_fma_f32 v21, v29, s55, v21
    v_fma_f32 v22, v30, s55, v22
    v_fma_f32 v23, v31, s55, v23
    v_cvt_pk_bf16_f32 v96, v16, v17
    v_cvt_pk_bf16_f32 v97, v18, v19
    v_cvt_pk_bf16_f32 v98, v20, v21
    v_cvt_pk_bf16_f32 v99, v22, v23
    s_add_u32 s62, s60, s64
    buffer_store_dwordx4 v[96:99], v3, s[16:19], s62 offen sc1
    v_fma_f32 v32, v40, s55, v32
    v_fma_f32 v33, v41, s55, v33
    v_fma_f32 v34, v42, s55, v34
    v_fma_f32 v35, v43, s55, v35
    v_fma_f32 v36, v44, s55, v36
    v_fma_f32 v37, v45, s55, v37
    v_fma_f32 v38, v46, s55, v38
    v_fma_f32 v39, v47, s55, v39
    v_cvt_pk_bf16_f32 v100, v32, v33
    v_cvt_pk_bf16_f32 v101, v34, v35
    v_cvt_pk_bf16_f32 v102, v36, v37
    v_cvt_pk_bf16_f32 v103, v38, v39
    s_add_u32 s62, s60, s65
    buffer_store_dwordx4 v[100:103], v3, s[16:19], s62 offen sc1
    v_fma_f32 v48, v56, s55, v48
    v_fma_f32 v49, v57, s55, v49
    v_fma_f32 v50, v58, s55, v50
    v_fma_f32 v51, v59, s55, v51
    v_fma_f32 v52, v60, s55, v52
    v_fma_f32 v53, v61, s55, v53
    v_fma_f32 v54, v62, s55, v54
    v_fma_f32 v55, v63, s55, v55
    v_cvt_pk_bf16_f32 v104, v48, v49
    v_cvt_pk_bf16_f32 v105, v50, v51
    v_cvt_pk_bf16_f32 v106, v52, v53
    v_cvt_pk_bf16_f32 v107, v54, v55
    s_add_u32 s62, s60, s66
    buffer_store_dwordx4 v[104:107], v3, s[16:19], s62 offen sc1
    v_fma_f32 v64, v72, s55, v64
    v_fma_f32 v65, v73, s55, v65
    v_fma_f32 v66, v74, s55, v66
    v_fma_f32 v67, v75, s55, v67
    v_fma_f32 v68, v76, s55, v68
    v_fma_f32 v69, v77, s55, v69
    v_fma_f32 v70, v78, s55, v70
    v_fma_f32 v71, v79, s55, v71
    v_cvt_pk_bf16_f32 v108, v64, v65
    v_cvt_pk_bf16_f32 v109, v66, v67
    v_cvt_pk_bf16_f32 v110, v68, v69
    v_cvt_pk_bf16_f32 v111, v70, v71
    s_add_u32 s62, s60, s67
    buffer_store_dwordx4 v[108:111], v3, s[16:19], s62 offen sc1
    v_fma_f32 v80, v88, s55, v80
    v_fma_f32 v81, v89, s55, v81
    v_fma_f32 v82, v90, s55, v82
    v_fma_f32 v83, v91, s55, v83
    v_fma_f32 v84, v92, s55, v84
    v_fma_f32 v85, v93, s55, v85
    v_fma_f32 v86, v94, s55, v86
    v_fma_f32 v87, v95, s55, v87
    v_cvt_pk_bf16_f32 v112, v80, v81
    v_cvt_pk_bf16_f32 v113, v82, v83
    v_cvt_pk_bf16_f32 v114, v84, v85
    v_cvt_pk_bf16_f32 v115, v86, v87
    s_add_u32 s62, s60, s68
    buffer_store_dwordx4 v[112:115], v3, s[16:19], s62 offen sc1
    s_mov_b32 s70, 1
K1_END:
    s_mov_b64 exec, -1
    s_getreg_b32 s60, hwreg(HW_REG_XCC_ID, 0, 4)
    s_add_u32 s60, s60, 1
    s_lshl_b32 s61, s46, 9
    s_lshl_b32 s62, s47, 4
    s_add_u32 s61, s61, s62
    s_lshl_b32 s62, s34, 2
    s_add_u32 s61, s61, s62
    s_add_u32 s61, s61, 8699904
    v_mov_b32 v13, 0
    v_mov_b32 v14, s60
    v_mov_b32 v15, 147488
K1_FW:
    ds_read_b32 v1, v15
    s_waitcnt lgkmcnt(0)
    v_cmp_eq_u32 vcc, 1, v1
    s_cmp_eq_u32 s70, 1
    s_cbranch_vccz K1_FW
    s_mov_b64 exec, 1
    s_cbranch_scc1 K1_FLAG
    s_waitcnt vmcnt(2)
    s_cmp_eq_u32 s69, 1
    s_cbranch_scc1 K1_FLAG
    s_waitcnt vmcnt(0)
K1_FLAG:
    buffer_store_dword v14, v13, s[16:19], s61 offen
    s_mov_b64 exec, -1
K1_DONE:
    s_cmp_ge_u32 s3, 8
    s_cbranch_scc1 K1_NOPBS
    s_barrier
K1_NOPBS:
    v_lshl_add_u32 v0, s3, 6, v0
    s_load_dwordx2 s[4:5], s[0:1], 88
    s_load_dwordx2 s[6:7], s[0:1], 72
    s_load_dwordx4 s[52:55], s[0:1], 8
    v_lshrrev_b32 v1, 6, v0
    v_and_b32 v0, 63, v0
    s_and_b32 s18, s2, 7
    s_lshr_b32 s19, s2, 3
    v_readfirstlane_b32 s22, v1
    s_lshl_b32 s20, s18, 2
    s_and_b32 s21, s19, 3
    s_add_u32 s20, s20, s21
    s_lshr_b32 s21, s2, 5
    s_mov_b32 s16, s20
    s_mov_b32 s17, s21
    s_mul_i32 s27, s16, 172032
    s_add_u32 s27, s27, 3145728
    v_and_b32 v1, 31, v0
    v_lshrrev_b32 v2, 5, v0
    v_lshlrev_b32 v3, 4, v0
    s_mov_b32 s15, 0x00020000
    s_mov_b32 s10, 17825792
    s_mov_b32 s11, 0x00020000
    s_cmp_ge_u32 s22, 8
    s_cbranch_scc1 K2_AUX
    s_and_b32 s23, s22, 3
    s_lshr_b32 s24, s22, 2
    s_lshl_b32 s25, s17, 3
    s_lshl_b32 s26, s23, 1
    s_add_u32 s25, s25, s26
    v_lshlrev_b32 v4, 3, v1
    v_lshlrev_b32 v5, 4, v1
    s_mul_i32 s28, s16, 81920
    s_mul_i32 s29, s25, 1280
    s_add_u32 s28, s28, s29
    s_add_u32 s28, s28, 0
    s_add_u32 s29, s24, 62
    s_mul_i32 s29, s29, 2688
    s_add_u32 s29, s29, s27
    s_waitcnt lgkmcnt(0)
    s_mov_b32 s8, s4
    s_and_b32 s9, s5, 0xffff
    s_mul_i32 s32, s24, 2688
    v_add_u32 v9, s32, v3
    v_add_u32 v14, 1024, v4
    v_mov_b32 v15, 1600
    v_cmp_gt_u32 s[50:51], 32, v0
    v_mul_u32_u24 v16, 336, v2
    v_lshl_add_u32 v16, v1, 4, v16
    v_cndmask_b32 v14, v15, v14, s[50:51]
    v_add_u32 v10, s32, v14
    v_add_u32 v16, 1280, v16
    v_add_u32 v11, s32, v16
    s_mov_b32 s48, 0x001fffff
    s_mov_b32 s49, 0x001fffff
    v_mov_b32 v12, 64544
    s_lshl_b32 s33, s22, 2
    s_add_u32 s33, s33, 64512
    v_mov_b32 v124, s33
    v_and_b32 v125, 7, v0
    v_lshlrev_b32 v125, 2, v125
    v_add_u32 v125, 64512, v125
    v_mov_b32 v126, 0
    ds_write_b32 v124, v126
    v_mov_b32 v64, 0
    v_mov_b32 v65, 0
    v_mov_b32 v66, 0
    v_mov_b32 v67, 0
    v_mov_b32 v68, 0
    v_mov_b32 v69, 0
    v_mov_b32 v70, 0
    v_mov_b32 v71, 0
    v_mov_b32 v72, 0
    v_mov_b32 v73, 0
    v_mov_b32 v74, 0
    v_mov_b32 v75, 0
    v_mov_b32 v76, 0
    v_mov_b32 v77, 0
    v_mov_b32 v78, 0
    v_mov_b32 v79, 0
    v_mov_b32 v80, 0
    v_mov_b32 v81, 0
    v_mov_b32 v82, 0
    v_mov_b32 v83, 0
    v_mov_b32 v84, 0
    v_mov_b32 v85, 0
    v_mov_b32 v86, 0
    v_mov_b32 v87, 0
    v_mov_b32 v88, 0
    v_mov_b32 v89, 0
    v_mov_b32 v90, 0
    v_mov_b32 v91, 0
    v_mov_b32 v92, 0
    v_mov_b32 v93, 0
    v_mov_b32 v94, 0
    v_mov_b32 v95, 0
    v_mov_b32 v56, 0
    v_mov_b32 v116, 0
    v_mov_b32 v57, 0
    v_mov_b32 v117, 0
    v_mov_b32 v58, 0
    v_mov_b32 v118, 0
    v_mov_b32 v59, 0
    v_mov_b32 v119, 0
    v_mov_b32 v60, 0
    v_mov_b32 v120, 0
    v_mov_b32 v61, 0
    v_mov_b32 v121, 0
    v_mov_b32 v62, 0
    v_mov_b32 v122, 0
    v_mov_b32 v63, 0
    v_mov_b32 v123, 0
    s_mov_b32 s73, 0
    s_cmp_eq_u32 s70, 1
    s_cbranch_scc0 K2_NOTF
    s_waitcnt vmcnt(0)
    v_mov_b32 v128, 163776
    v_mov_b32 v129, 1
    s_mov_b64 exec, 1
    ds_add_rtn_u32 v130, v128, v129
    s_waitcnt lgkmcnt(0)
    v_cmp_eq_u32 vcc, s71, v130
    s_mov_b64 exec, -1
    s_lshl_b32 s72, s2, 2
    s_add_u32 s72, s72, 8732672
    s_mov_b32 s73, vcc_lo
    v_lshlrev_b32 v128, 10, v0
K2_NOTF:
    s_barrier
    buffer_load_dwordx4 v[96:99], v3, s[8:11], s28 offen sc1
    buffer_load_dwordx4 v[104:107], v5, s[8:11], s28 offen offset:2048 sc1
    buffer_load_dwordx4 v[100:103], v3, s[8:11], s28 offen offset:1024 sc1
    buffer_load_dwordx4 v[108:111], v3, s[8:11], s29 offen sc1
    buffer_load_dwordx2 v[112:113], v4, s[8:11], s29 offen offset:1024 sc1
    s_cmp_eq_u32 s73, 0
    s_cbranch_scc1 K2_NOX
    s_mov_b64 exec, 0xff
    buffer_store_dword v129, v128, s[8:11], s72 offen sc1
    s_mov_b64 exec, -1
    s_waitcnt vmcnt(1)
    s_branch K2_XD
K2_NOX:
    s_waitcnt vmcnt(0)
K2_XD:
    v_mov_b32 v15, 0x3f803f80
    v_cndmask_b32 v104, 0, v104, s[50:51]
    v_cndmask_b32 v105, 0, v105, s[50:51]
    v_cndmask_b32 v106, 0, v106, s[50:51]
    v_cndmask_b32 v107, 0, v107, s[50:51]
    v_cndmask_b32 v112, v15, v112, s[50:51]
    v_cndmask_b32 v113, v15, v113, s[50:51]
    v_dot2_f32_bf16 v16, v96, v96, 0
    v_dot2_f32_bf16 v18, v100, v100, 0
    v_dot2_f32_bf16 v16, v97, v97, v16
    v_dot2_f32_bf16 v18, v101, v101, v18
    v_dot2_f32_bf16 v16, v98, v98, v16
    v_dot2_f32_bf16 v18, v102, v102, v18
    v_dot2_f32_bf16 v16, v99, v99, v16
    v_dot2_f32_bf16 v18, v103, v103, v18
    v_dot2_f32_bf16 v16, v104, v104, v16
    v_dot2_f32_bf16 v18, v106, v106, v18
    v_dot2_f32_bf16 v16, v105, v105, v16
    v_dot2_f32_bf16 v18, v107, v107, v18
K2_KM:
    ds_read_b32 v13, v12 offset:16
    s_waitcnt lgkmcnt(0)
    v_cmp_eq_u32 vcc, -1, v13
    s_nop 1
    s_cbranch_vccnz K2_KM
    v_mov_b32 v17, v16
    v_mov_b32 v19, v18
    s_nop 1
    v_permlane32_swap_b32 v16, v17
    v_permlane32_swap_b32 v18, v19
    s_nop 1
    v_add_f32 v16, v16, v17
    v_add_f32 v18, v18, v19
    v_mul_f32 v16, v13, v16
    v_mul_f32 v18, v13, v18
    v_sqrt_f32 v16, v16
    v_sqrt_f32 v18, v18
    s_nop 0
    v_sub_f32 v16, 0x42800000, v16
    v_sub_f32 v18, 0x42800000, v18
    v_and_b32 v20, 0xffff0000, v16
    v_sub_f32 v21, v16, v20
    v_and_b32 v22, 0xffff0000, v21
    v_sub_f32 v23, v21, v22
    v_lshrrev_b32 v20, 16, v20
    v_or_b32 v20, v20, v22
    v_lshrrev_b32 v23, 16, v23
    v_cndmask_b32 v104, v20, v104, s[50:51]
    v_cndmask_b32 v105, v23, v105, s[50:51]
    v_and_b32 v20, 0xffff0000, v18
    v_sub_f32 v21, v18, v20
    v_and_b32 v22, 0xffff0000, v21
    v_sub_f32 v23, v21, v22
    v_lshrrev_b32 v20, 16, v20
    v_or_b32 v20, v20, v22
    v_lshrrev_b32 v23, 16, v23
    v_cndmask_b32 v106, v20, v106, s[50:51]
    v_cndmask_b32 v107, v23, v107, s[50:51]
    s_nop 1
    v_mfma_f32_32x32x8_bf16 v[16:31], v[112:113], v[104:105], 0
    v_mfma_f32_32x32x16_bf16 v[16:31], v[108:111], v[96:99], v[16:31]
    s_mov_b32 s42, 0
    s_mov_b32 s44, 0
    s_mov_b32 s68, 0
    s_waitcnt lgkmcnt(0)
    s_barrier
    s_nop 7
K2_LOOP:
    s_setprio 3
    v_mfma_f32_32x32x8_bf16 v[32:47], v[112:113], v[106:107], 0
    v_exp_f32 v16, v16
    v_exp_f32 v17, v17
    v_exp_f32 v18, v18
    v_exp_f32 v19, v19
    v_cvt_pk_bf16_f32 v48, v16, v17
    v_cvt_pk_bf16_f32 v49, v18, v19
    v_mfma_f32_32x32x16_bf16 v[32:47], v[108:111], v[100:103], v[32:47]
    ds_read_b128 v[108:111], v9 offset:0
    ds_read_b64 v[112:113], v10 offset:0
    v_exp_f32 v20, v20
    v_exp_f32 v21, v21
    v_exp_f32 v22, v22
    v_exp_f32 v23, v23
    v_cvt_pk_bf16_f32 v50, v20, v21
    v_cvt_pk_bf16_f32 v51, v22, v23
    v_mfma_f32_32x32x16_bf16 v[80:95], v[116:119], v[56:59], v[80:95]
    v_exp_f32 v24, v24
    v_exp_f32 v25, v25
    v_exp_f32 v26, v26
    v_exp_f32 v27, v27
    v_cvt_pk_bf16_f32 v52, v24, v25
    v_cvt_pk_bf16_f32 v53, v26, v27
    v_mfma_f32_32x32x16_bf16 v[80:95], v[120:123], v[60:63], v[80:95]
    s_mov_b64 exec, s[48:49]
    ds_read_b128 v[116:119], v11 offset:0
    ds_read_b128 v[120:123], v11 offset:672
    s_mov_b64 exec, -1
    v_exp_f32 v28, v28
    v_exp_f32 v29, v29
    v_exp_f32 v30, v30
    v_exp_f32 v31, v31
    v_cvt_pk_bf16_f32 v54, v28, v29
    v_cvt_pk_bf16_f32 v55, v30, v31
    v_add_u32 v126, 1, v126
    ds_write_b32 v124, v126
    s_waitcnt lgkmcnt(3)
    v_mfma_f32_32x32x8_bf16 v[16:31], v[112:113], v[104:105], 0
    v_exp_f32 v32, v32
    v_exp_f32 v33, v33
    v_exp_f32 v34, v34
    v_exp_f32 v35, v35
    v_cvt_pk_bf16_f32 v56, v32, v33
    v_cvt_pk_bf16_f32 v57, v34, v35
    v_mfma_f32_32x32x16_bf16 v[16:31], v[108:111], v[96:99], v[16:31]
    v_exp_f32 v36, v36
    v_exp_f32 v37, v37
    v_exp_f32 v38, v38
    v_exp_f32 v39, v39
    v_cvt_pk_bf16_f32 v58, v36, v37
    v_cvt_pk_bf16_f32 v59, v38, v39
    s_waitcnt lgkmcnt(1)
    v_mfma_f32_32x32x16_bf16 v[64:79], v[116:119], v[48:51], v[64:79]
    v_exp_f32 v40, v40
    v_exp_f32 v41, v41
    v_exp_f32 v42, v42
    v_exp_f32 v43, v43
    v_cvt_pk_bf16_f32 v60, v40, v41
    v_cvt_pk_bf16_f32 v61, v42, v43
    v_mfma_f32_32x32x16_bf16 v[64:79], v[120:123], v[52:55], v[64:79]
    v_exp_f32 v44, v44
    v_exp_f32 v45, v45
    v_exp_f32 v46, v46
    v_exp_f32 v47, v47
    v_cvt_pk_bf16_f32 v62, v44, v45
    v_cvt_pk_bf16_f32 v63, v46, v47
    s_setprio 2
    v_mfma_f32_32x32x8_bf16 v[32:47], v[112:113], v[106:107], 0
    v_exp_f32 v16, v16
    v_exp_f32 v17, v17
    v_exp_f32 v18, v18
    v_exp_f32 v19, v19
    v_cvt_pk_bf16_f32 v48, v16, v17
    v_cvt_pk_bf16_f32 v49, v18, v19
    v_mfma_f32_32x32x16_bf16 v[32:47], v[108:111], v[100:103], v[32:47]
    ds_read_b128 v[108:111], v9 offset:5376
    ds_read_b64 v[112:113], v10 offset:5376
    v_exp_f32 v20, v20
    v_exp_f32 v21, v21
    v_exp_f32 v22, v22
    v_exp_f32 v23, v23
    v_cvt_pk_bf16_f32 v50, v20, v21
    v_cvt_pk_bf16_f32 v51, v22, v23
    v_mfma_f32_32x32x16_bf16 v[80:95], v[116:119], v[56:59], v[80:95]
    v_exp_f32 v24, v24
    v_exp_f32 v25, v25
    v_exp_f32 v26, v26
    v_exp_f32 v27, v27
    v_cvt_pk_bf16_f32 v52, v24, v25
    v_cvt_pk_bf16_f32 v53, v26, v27
    v_mfma_f32_32x32x16_bf16 v[80:95], v[120:123], v[60:63], v[80:95]
    s_mov_b64 exec, s[48:49]
    ds_read_b128 v[116:119], v11 offset:5376
    ds_read_b128 v[120:123], v11 offset:6048
    s_mov_b64 exec, -1
    v_exp_f32 v28, v28
    v_exp_f32 v29, v29
    v_exp_f32 v30, v30
    v_exp_f32 v31, v31
    v_cvt_pk_bf16_f32 v54, v28, v29
    v_cvt_pk_bf16_f32 v55, v30, v31
    s_add_u32 s42, s42, 1
    s_add_u32 s44, s44, 1
    s_cmp_eq_u32 s44, 3
    s_cselect_b32 s44, 0, s44
    s_mov_b32 s43, 21504
    s_cselect_b32 s43, 4294924288, s43
    s_waitcnt lgkmcnt(2)
    v_mfma_f32_32x32x8_bf16 v[16:31], v[112:113], v[104:105], 0
    v_exp_f32 v32, v32
    v_exp_f32 v33, v33
    v_exp_f32 v34, v34
    v_exp_f32 v35, v35
    v_cvt_pk_bf16_f32 v56, v32, v33
    v_cvt_pk_bf16_f32 v57, v34, v35
    v_mfma_f32_32x32x16_bf16 v[16:31], v[108:111], v[96:99], v[16:31]
    v_exp_f32 v36, v36
    v_exp_f32 v37, v37
    v_exp_f32 v38, v38
    v_exp_f32 v39, v39
    v_cvt_pk_bf16_f32 v58, v36, v37
    v_cvt_pk_bf16_f32 v59, v38, v39
    s_waitcnt lgkmcnt(0)
    v_mfma_f32_32x32x16_bf16 v[64:79], v[116:119], v[48:51], v[64:79]
    v_exp_f32 v40, v40
    v_exp_f32 v41, v41
    v_exp_f32 v42, v42
    v_exp_f32 v43, v43
    v_cvt_pk_bf16_f32 v60, v40, v41
    v_cvt_pk_bf16_f32 v61, v42, v43
    v_mfma_f32_32x32x16_bf16 v[64:79], v[120:123], v[52:55], v[64:79]
    v_exp_f32 v44, v44
    v_exp_f32 v45, v45
    v_exp_f32 v46, v46
    v_exp_f32 v47, v47
    v_cvt_pk_bf16_f32 v62, v44, v45
    v_cvt_pk_bf16_f32 v63, v46, v47
    s_setprio 1
    v_mfma_f32_32x32x8_bf16 v[32:47], v[112:113], v[106:107], 0
    v_exp_f32 v16, v16
    v_exp_f32 v17, v17
    v_exp_f32 v18, v18
    v_exp_f32 v19, v19
    v_cvt_pk_bf16_f32 v48, v16, v17
    v_cvt_pk_bf16_f32 v49, v18, v19
    v_mfma_f32_32x32x16_bf16 v[32:47], v[108:111], v[100:103], v[32:47]
    ds_read_b128 v[108:111], v9 offset:10752
    ds_read_b64 v[112:113], v10 offset:10752
    v_exp_f32 v20, v20
    v_exp_f32 v21, v21
    v_exp_f32 v22, v22
    v_exp_f32 v23, v23
    v_cvt_pk_bf16_f32 v50, v20, v21
    v_cvt_pk_bf16_f32 v51, v22, v23
    v_mfma_f32_32x32x16_bf16 v[80:95], v[116:119], v[56:59], v[80:95]
    v_exp_f32 v24, v24
    v_exp_f32 v25, v25
    v_exp_f32 v26, v26
    v_exp_f32 v27, v27
    v_cvt_pk_bf16_f32 v52, v24, v25
    v_cvt_pk_bf16_f32 v53, v26, v27
    v_mfma_f32_32x32x16_bf16 v[80:95], v[120:123], v[60:63], v[80:95]
    s_mov_b64 exec, s[48:49]
    ds_read_b128 v[116:119], v11 offset:10752
    ds_read_b128 v[120:123], v11 offset:11424
    s_mov_b64 exec, -1
    v_exp_f32 v28, v28
    v_exp_f32 v29, v29
    v_exp_f32 v30, v30
    v_exp_f32 v31, v31
    v_cvt_pk_bf16_f32 v54, v28, v29
    v_cvt_pk_bf16_f32 v55, v30, v31
    s_waitcnt lgkmcnt(2)
    v_mfma_f32_32x32x8_bf16 v[16:31], v[112:113], v[104:105], 0
    v_exp_f32 v32, v32
    v_exp_f32 v33, v33
    v_exp_f32 v34, v34
    v_exp_f32 v35, v35
    v_cvt_pk_bf16_f32 v56, v32, v33
    v_cvt_pk_bf16_f32 v57, v34, v35
    v_mfma_f32_32x32x16_bf16 v[16:31], v[108:111], v[96:99], v[16:31]
    v_exp_f32 v36, v36
    v_exp_f32 v37, v37
    v_exp_f32 v38, v38
    v_exp_f32 v39, v39
    v_cvt_pk_bf16_f32 v58, v36, v37
    v_cvt_pk_bf16_f32 v59, v38, v39
    s_waitcnt lgkmcnt(0)
    v_mfma_f32_32x32x16_bf16 v[64:79], v[116:119], v[48:51], v[64:79]
    v_exp_f32 v40, v40
    v_exp_f32 v41, v41
    v_exp_f32 v42, v42
    v_exp_f32 v43, v43
    v_cvt_pk_bf16_f32 v60, v40, v41
    v_cvt_pk_bf16_f32 v61, v42, v43
    v_mfma_f32_32x32x16_bf16 v[64:79], v[120:123], v[52:55], v[64:79]
    v_exp_f32 v44, v44
    v_exp_f32 v45, v45
    v_exp_f32 v46, v46
    v_exp_f32 v47, v47
    v_cvt_pk_bf16_f32 v62, v44, v45
    v_cvt_pk_bf16_f32 v63, v46, v47
    s_setprio 0
    v_mfma_f32_32x32x8_bf16 v[32:47], v[112:113], v[106:107], 0
    v_exp_f32 v16, v16
    v_exp_f32 v17, v17
    v_exp_f32 v18, v18
    v_exp_f32 v19, v19
    v_cvt_pk_bf16_f32 v48, v16, v17
    v_cvt_pk_bf16_f32 v49, v18, v19
    v_mfma_f32_32x32x16_bf16 v[32:47], v[108:111], v[100:103], v[32:47]
    ds_read_b128 v[108:111], v9 offset:16128
    ds_read_b64 v[112:113], v10 offset:16128
    v_exp_f32 v20, v20
    v_exp_f32 v21, v21
    v_exp_f32 v22, v22
    v_exp_f32 v23, v23
    v_cvt_pk_bf16_f32 v50, v20, v21
    v_cvt_pk_bf16_f32 v51, v22, v23
    v_mfma_f32_32x32x16_bf16 v[80:95], v[116:119], v[56:59], v[80:95]
    v_exp_f32 v24, v24
    v_exp_f32 v25, v25
    v_exp_f32 v26, v26
    v_exp_f32 v27, v27
    v_cvt_pk_bf16_f32 v52, v24, v25
    v_cvt_pk_bf16_f32 v53, v26, v27
    v_mfma_f32_32x32x16_bf16 v[80:95], v[120:123], v[60:63], v[80:95]
    s_mov_b64 exec, s[48:49]
    ds_read_b128 v[116:119], v11 offset:16128
    ds_read_b128 v[120:123], v11 offset:16800
    s_mov_b64 exec, -1
    v_exp_f32 v28, v28
    v_exp_f32 v29, v29
    v_exp_f32 v30, v30
    v_exp_f32 v31, v31
    v_cvt_pk_bf16_f32 v54, v28, v29
    v_cvt_pk_bf16_f32 v55, v30, v31
    s_waitcnt lgkmcnt(2)
    v_mfma_f32_32x32x8_bf16 v[16:31], v[112:113], v[104:105], 0
    v_exp_f32 v32, v32
    v_exp_f32 v33, v33
    v_exp_f32 v34, v34
    v_exp_f32 v35, v35
    v_cvt_pk_bf16_f32 v56, v32, v33
    v_cvt_pk_bf16_f32 v57, v34, v35
    v_mfma_f32_32x32x16_bf16 v[16:31], v[108:111], v[96:99], v[16:31]
    v_exp_f32 v36, v36
    v_exp_f32 v37, v37
    v_exp_f32 v38, v38
    v_exp_f32 v39, v39
    v_cvt_pk_bf16_f32 v58, v36, v37
    v_cvt_pk_bf16_f32 v59, v38, v39
    s_waitcnt lgkmcnt(0)
    v_mfma_f32_32x32x16_bf16 v[64:79], v[116:119], v[48:51], v[64:79]
    ds_read_b32 v127, v12
    v_exp_f32 v40, v40
    v_exp_f32 v41, v41
    v_exp_f32 v42, v42
    v_exp_f32 v43, v43
    v_cvt_pk_bf16_f32 v60, v40, v41
    v_cvt_pk_bf16_f32 v61, v42, v43
    v_mfma_f32_32x32x16_bf16 v[64:79], v[120:123], v[52:55], v[64:79]
    v_add_u32 v9, s43, v9
    v_add_u32 v10, s43, v10
    v_add_u32 v11, s43, v11
    v_exp_f32 v44, v44
    v_exp_f32 v45, v45
    v_exp_f32 v46, v46
    v_exp_f32 v47, v47
    v_cvt_pk_bf16_f32 v62, v44, v45
    v_cvt_pk_bf16_f32 v63, v46, v47
    s_waitcnt lgkmcnt(0)
    v_cmp_gt_u32 vcc, v127, v126
    s_cmp_lt_u32 s42, 8
    s_cbranch_vccz K2_SPIN
    s_cbranch_scc1 K2_LOOP
    s_branch K2_LOOPEND
K2_SPIN:
    s_sleep 2
    ds_read_b32 v127, v12
    s_waitcnt lgkmcnt(0)
    v_cmp_gt_u32 vcc, v127, v126
    s_nop 1
    s_cbranch_vccz K2_SPIN
    s_cbranch_scc1 K2_LOOP
    s_branch K2_LOOPEND
K2_LOOPEND:
    v_mfma_f32_32x32x16_bf16 v[80:95], v[116:119], v[56:59], v[80:95]
    v_mfma_f32_32x32x16_bf16 v[80:95], v[120:123], v[60:63], v[80:95]
    s_mul_i32 s34, s23, 3072
    s_mul_i32 s47, s24, 43008
    s_add_u32 s56, s34, s47
    v_add_u32 v13, s56, v3
    s_sub_u32 s47, 43008, s47
    s_add_u32 s56, s34, s47
    v_add_u32 v14, s56, v3
    s_add_u32 s46, s25, s24
    s_mul_i32 s35, s46, 40960
    s_mul_i32 s36, s16, 1280
    s_add_u32 s36, s36, s35
    s_add_u32 s36, s36, 11272192
    s_nop 3
    s_cmp_eq_u32 s24, 0
    s_cbranch_scc0 K2_X1
    ds_write_b128 v13, v[80:83] offset:0
    ds_write_b128 v13, v[84:87] offset:1024
    ds_write_b128 v13, v[88:91] offset:2048
    s_branch K2_X2
K2_X1:
    ds_write_b128 v13, v[64:67] offset:0
    ds_write_b128 v13, v[68:71] offset:1024
    ds_write_b128 v13, v[72:75] offset:2048
    s_nop 4
    v_mov_b32 v64, v80
    v_mov_b32 v65, v81
    v_mov_b32 v66, v82
    v_mov_b32 v67, v83
    v_mov_b32 v68, v84
    v_mov_b32 v69, v85
    v_mov_b32 v70, v86
    v_mov_b32 v71, v87
    v_mov_b32 v72, v88
    v_mov_b32 v73, v89
    v_mov_b32 v74, v90
    v_mov_b32 v75, v91
K2_X2:
    s_xor_b32 s56, s22, 4
    s_lshl_b32 s56, s56, 2
    s_add_u32 s56, s56, 64512
    v_mov_b32 v128, s56
    v_mov_b32 v129, 64548
    v_mov_b32 v130, 9
    v_mov_b32 v126, 9
    v_cndmask_b32 v128, v129, v128, s[50:51]
    v_cndmask_b32 v130, 1, v130, s[50:51]
    s_waitcnt lgkmcnt(0)
    ds_write_b32 v124, v126
K2_XW:
    ds_read_b32 v131, v128
    s_waitcnt lgkmcnt(0)
    v_cmp_lt_u32 vcc, v131, v130
    s_nop 1
    s_cbranch_vccz K2_XGO
    s_sleep 1
    s_branch K2_XW
K2_XGO:
    ds_read_b128 v[16:19], v14 offset:0
    ds_read_b128 v[20:23], v14 offset:1024
    ds_read_b128 v[24:27], v14 offset:2048
    s_waitcnt lgkmcnt(0)
    v_add_f32 v72, v72, v24
    v_mov_b32 v28, v72
    v_mov_b32 v29, v72
    v_mov_b32 v30, 0x71800000
    v_add_f32 v64, v64, v16
    v_add_f32 v65, v65, v17
    v_permlane32_swap_b32 v28, v29
    v_add_f32 v66, v66, v18
    v_add_f32 v67, v67, v19
    v_add_f32 v68, v68, v20
    v_cmp_nle_f32 vcc, 0x0d800000, v29
    v_cmp_lt_f32 s[56:57], v30, v29
    v_rcp_f32 v29, v29
    v_add_f32 v69, v69, v21
    v_add_f32 v70, v70, v22
    v_add_f32 v71, v71, v23
    v_add_f32 v73, v73, v25
    v_add_f32 v74, v74, v26
    v_add_f32 v75, v75, v27
    s_or_b64 s[56:57], s[56:57], vcc
    s_cbranch_scc1 K2_SLOW
K2_FINAL:
    v_mul_f32 v64, v64, v29
    v_mul_f32 v65, v65, v29
    v_mul_f32 v66, v66, v29
    v_mul_f32 v67, v67, v29
    v_mul_f32 v68, v68, v29
    v_mul_f32 v69, v69, v29
    v_mul_f32 v70, v70, v29
    v_mul_f32 v71, v71, v29
    v_mul_f32 v72, v72, v29
    v_mul_f32 v73, v73, v29
    v_mul_f32 v74, v74, v29
    v_mul_f32 v75, v75, v29
    v_cvt_pk_bf16_f32 v52, v64, v65
    v_cvt_pk_bf16_f32 v53, v66, v67
    v_cvt_pk_bf16_f32 v54, v68, v69
    v_cvt_pk_bf16_f32 v55, v70, v71
    v_cvt_pk_bf16_f32 v56, v72, v73
    v_cvt_pk_bf16_f32 v57, v74, v75
    buffer_store_dwordx4 v[52:55], v3, s[8:11], s36 offen sc1
    s_mov_b64 exec, s[50:51]
    buffer_store_dwordx2 v[56:57], v4, s[8:11], s36 offen offset:1024 sc1
    s_mov_b64 exec, -1
    s_nop 0
    v_mov_b32 v126, 10
    ds_write_b32 v124, v126
    ds_read_b32 v131, v12 offset:4
    s_waitcnt lgkmcnt(0)
    v_cmp_eq_u32 vcc, 3, v131
    s_nop 1
    s_cbranch_vccz K2_YDONE
    s_mov_b32 s68, 1
    s_lshl_b32 s56, s20, 1
    s_lshr_b32 s57, s23, 1
    s_add_u32 s56, s56, s57
    s_lshr_b32 s57, s56, 2
    s_lshl_b32 s57, s57, 6
    s_and_b32 s56, s56, 3
    s_lshl_b32 s56, s56, 3
    s_add_u32 s56, s56, s57
    v_and_b32 v130, 3, v0
    v_bfe_u32 v136, v0, 2, 1
    v_lshl_add_u32 v130, v136, 5, v130
    v_bfe_u32 v136, v0, 3, 1
    v_lshl_add_u32 v130, v136, 2, v130
    v_add_u32 v130, s56, v130
    v_mov_b32 v131, v130
    s_and_b32 s57, s23, 1
    s_cmp_eq_u32 s57, 0
    s_cbranch_scc1 TOK130_D
    v_cmp_eq_u32 vcc, 0, v130
    v_mov_b32 v136, 1024
    s_nop 0
    v_cndmask_b32 v130, v130, v136, vcc
    v_sub_u32 v131, 2048, v130
TOK130_D:
    v_lshrrev_b32 v129, 4, v0
    s_mul_i32 s58, s21, 80
    s_mul_i32 s59, s24, 48
    s_add_u32 s58, s58, s59
    v_lshl_add_u32 v128, v129, 2, s58
    s_movk_i32 s59, 1408
    v_mul_u32_u24 v130, s59, v130
    v_sub_u32 v129, 605, v128
    s_cmp_ge_u32 s21, 4
    s_cselect_b64 s[64:65], -1, 0
    s_cselect_b32 s58, 1, 0
    s_xor_b32 s58, s58, s57
    s_mul_i32 s58, s58, 1572864
    s_add_u32 s58, s58, 13893632
    v_cndmask_b32 v129, v128, v129, s[64:65]
    v_lshl_add_u32 v130, v129, 2, v130
    v_add_u32 v130, s58, v130
    v_lshlrev_b32 v131, 2, v131
    s_mov_b32 s66, 8716288
    buffer_load_dword v164, v131, s[8:11], s66 offen
    buffer_load_dwordx4 v[152:155], v130, s[8:11], 0 offen offset:0 sc1
    buffer_load_dwordx4 v[156:159], v130, s[8:11], 0 offen offset:64 sc1
    buffer_load_dwordx4 v[160:163], v130, s[8:11], 0 offen offset:128 sc1
K2_YDONE:
    s_lshl_b32 s56, s24, 13
    v_add_u32 v4, s56, v3
    v_add_u32 v5, 61440, v4
    v_add_u32 v6, 122880, v4
    s_lshl_b32 s56, s24, 11
    v_add_u32 v4, s56, v3
    v_add_u32 v12, 77824, v4
    v_add_u32 v14, 139264, v4
    s_mul_i32 s67, s21, 102400
    s_add_u32 s67, s67, 10354688
    s_lshl_b32 s56, s20, 1
    s_lshr_b32 s57, s23, 1
    s_add_u32 s56, s56, s57
    s_lshr_b32 s57, s56, 2
    s_lshl_b32 s57, s57, 6
    s_and_b32 s56, s56, 3
    s_lshl_b32 s56, s56, 3
    s_add_u32 s56, s56, s57
    v_and_b32 v13, 3, v0
    v_bfe_u32 v9, v0, 2, 1
    v_lshl_add_u32 v13, v9, 5, v13
    v_bfe_u32 v9, v0, 3, 1
    v_lshl_add_u32 v13, v9, 2, v13
    v_add_u32 v13, s56, v13
    v_mov_b32 v11, v13
    s_and_b32 s57, s23, 1
    s_cmp_eq_u32 s57, 0
    s_cbranch_scc1 TOK13_D
    v_cmp_eq_u32 vcc, 0, v13
    v_mov_b32 v9, 1024
    s_nop 0
    v_cndmask_b32 v13, v13, v9, vcc
    v_sub_u32 v11, 2048, v13
TOK13_D:
    v_and_b32 v9, 15, v0
    v_lshrrev_b32 v10, 4, v0
    s_mul_i32 s58, s21, 80
    s_mul_i32 s59, s24, 48
    s_add_u32 s58, s58, s59
    v_lshl_add_u32 v13, v10, 2, s58
    s_movk_i32 s59, 1280
    v_mul_u32_u24 v11, s59, v11
    v_lshl_add_u32 v11, v13, 1, v11
    s_mov_b32 s12, s6
    s_and_b32 s13, s7, 0xffff
    s_mov_b32 s14, 2621440
    s_lshl_b32 s57, s20, 1
    s_lshr_b32 s58, s23, 1
    s_add_u32 s57, s57, s58
    s_mul_i32 s51, s57, 40960
    s_add_u32 s51, s51, 11272192
    s_and_b32 s58, s23, 1
    s_lshl_b32 s58, s58, 4
    v_add_u32 v9, s58, v9
    v_lshrrev_b32 v15, 1, v10
    v_mul_u32_u24 v15, 1280, v15
    v_and_b32 v13, 1, v10
    v_lshl_add_u32 v15, v13, 9, v15
    v_lshl_add_u32 v7, v9, 4, v15
    v_mul_u32_u24 v8, 2560, v10
    v_lshl_add_u32 v8, v9, 3, v8
    v_add_u32 v8, 1024, v8
    s_mul_i32 s58, s24, 20480
    s_add_u32 s52, s51, s58
    s_mov_b32 s69, 0
    s_cmp_eq_u32 s24, 0
    s_cbranch_scc0 K3_W1
    buffer_load_dwordx4 v[16:19], v3, s[8:11], s67 offen offset:0
    buffer_load_dwordx4 v[20:23], v3, s[8:11], s67 offen offset:1024
    buffer_load_dwordx4 v[24:27], v3, s[8:11], s67 offen offset:2048
    buffer_load_dwordx4 v[28:31], v3, s[8:11], s67 offen offset:3072
    s_branch K3_W2
K3_W1:
K3_W2:
    s_barrier
    s_add_u32 s53, s52, 10240
    buffer_load_dwordx4 v[52:55], v7, s[8:11], s53 offen sc1
    s_add_u32 s53, s52, 12800
    buffer_load_dwordx4 v[56:59], v7, s[8:11], s53 offen sc1
    s_add_u32 s53, s52, 15360
    buffer_load_dwordx4 v[60:63], v7, s[8:11], s53 offen sc1
    s_add_u32 s53, s52, 17920
    buffer_load_dwordx4 v[64:67], v7, s[8:11], s53 offen sc1
    s_add_u32 s53, s52, 0
    buffer_load_dwordx2 v[68:69], v8, s[8:11], s53 offen sc1
    buffer_load_dwordx2 v[70:71], v8, s[8:11], s53 offen offset:1280 sc1
    s_add_u32 s53, s52, 10240
    buffer_load_dwordx2 v[72:73], v8, s[8:11], s53 offen sc1
    buffer_load_dwordx2 v[74:75], v8, s[8:11], s53 offen offset:1280 sc1
    s_add_u32 s53, s52, 0
    buffer_load_dwordx4 v[76:79], v7, s[8:11], s53 offen sc1
    s_add_u32 s53, s52, 2560
    buffer_load_dwordx4 v[80:83], v7, s[8:11], s53 offen sc1
    s_add_u32 s53, s52, 5120
    buffer_load_dwordx4 v[84:87], v7, s[8:11], s53 offen sc1
    s_add_u32 s53, s52, 7680
    buffer_load_dwordx4 v[88:91], v7, s[8:11], s53 offen sc1
K3_RETRY:
    v_mov_b32 v166, 0
    ds_read_b128 v[92:95], v5 offset:4096
    ds_read_b128 v[96:99], v5 offset:24576
    ds_read_b128 v[100:103], v5 offset:45056
    ds_read_b128 v[104:107], v6 offset:4096
    ds_read_b128 v[108:111], v6 offset:24576
    ds_read_b128 v[112:115], v5 offset:5120
    ds_read_b128 v[116:119], v5 offset:25600
    ds_read_b128 v[120:123], v5 offset:46080
    ds_read_b128 v[124:127], v6 offset:5120
    ds_read_b128 v[128:131], v6 offset:25600
    ds_read_b128 v[132:135], v5 offset:6144
    ds_read_b128 v[136:139], v5 offset:26624
    ds_read_b128 v[140:143], v5 offset:47104
    ds_read_b128 v[144:147], v6 offset:6144
    ds_read_b128 v[148:151], v6 offset:26624
    s_cmp_eq_u32 s24, 0
    s_cbranch_scc1 K3_W3
    ds_read_b128 v[16:19], v5 offset:0
    ds_read_b128 v[20:23], v5 offset:1024
    ds_read_b128 v[24:27], v5 offset:2048
    ds_read_b128 v[28:31], v5 offset:3072
K3_W3:
    s_waitcnt vmcnt(11) lgkmcnt(0)
    v_mfma_f32_16x16x32_bf16 v[32:35], v[92:95], v[52:55], 0
    v_mfma_f32_16x16x32_bf16 v[36:39], v[96:99], v[52:55], 0
    v_mfma_f32_16x16x32_bf16 v[40:43], v[100:103], v[52:55], 0
    v_mfma_f32_16x16x32_bf16 v[44:47], v[104:107], v[52:55], 0
    v_mfma_f32_16x16x32_bf16 v[48:51], v[108:111], v[52:55], 0
    ds_read_b128 v[92:95], v5 offset:7168
    ds_read_b128 v[96:99], v5 offset:27648
    ds_read_b128 v[100:103], v5 offset:48128
    ds_read_b128 v[104:107], v6 offset:7168
    ds_read_b128 v[108:111], v6 offset:27648
    v_max3_u32 v166, v52, v53, v166
    v_max3_u32 v166, v54, v55, v166
    s_waitcnt vmcnt(10) lgkmcnt(5)
    v_mfma_f32_16x16x32_bf16 v[32:35], v[112:115], v[56:59], v[32:35]
    v_mfma_f32_16x16x32_bf16 v[36:39], v[116:119], v[56:59], v[36:39]
    v_mfma_f32_16x16x32_bf16 v[40:43], v[120:123], v[56:59], v[40:43]
    v_mfma_f32_16x16x32_bf16 v[44:47], v[124:127], v[56:59], v[44:47]
    v_mfma_f32_16x16x32_bf16 v[48:51], v[128:131], v[56:59], v[48:51]
    ds_read_b128 v[112:115], v12 offset:0
    ds_read_b128 v[116:119], v12 offset:20480
    ds_read_b128 v[120:123], v12 offset:40960
    ds_read_b128 v[124:127], v14 offset:0
    ds_read_b128 v[128:131], v14 offset:20480
    v_max3_u32 v166, v56, v57, v166
    v_max3_u32 v166, v58, v59, v166
    s_waitcnt vmcnt(9) lgkmcnt(10)
    v_mfma_f32_16x16x32_bf16 v[32:35], v[132:135], v[60:63], v[32:35]
    v_mfma_f32_16x16x32_bf16 v[36:39], v[136:139], v[60:63], v[36:39]
    v_mfma_f32_16x16x32_bf16 v[40:43], v[140:143], v[60:63], v[40:43]
    v_mfma_f32_16x16x32_bf16 v[44:47], v[144:147], v[60:63], v[44:47]
    v_mfma_f32_16x16x32_bf16 v[48:51], v[148:151], v[60:63], v[48:51]
    ds_read_b128 v[132:135], v12 offset:1024
    ds_read_b128 v[136:139], v12 offset:21504
    ds_read_b128 v[140:143], v12 offset:41984
    ds_read_b128 v[144:147], v14 offset:1024
    ds_read_b128 v[148:151], v14 offset:21504
    v_max3_u32 v166, v60, v61, v166
    v_max3_u32 v166, v62, v63, v166
    s_waitcnt vmcnt(8) lgkmcnt(10)
    v_mfma_f32_16x16x32_bf16 v[32:35], v[92:95], v[64:67], v[32:35]
    v_mfma_f32_16x16x32_bf16 v[36:39], v[96:99], v[64:67], v[36:39]
    v_mfma_f32_16x16x32_bf16 v[40:43], v[100:103], v[64:67], v[40:43]
    v_mfma_f32_16x16x32_bf16 v[44:47], v[104:107], v[64:67], v[44:47]
    v_mfma_f32_16x16x32_bf16 v[48:51], v[108:111], v[64:67], v[48:51]
    ds_read_b128 v[96:99], v5 offset:20480
    ds_read_b128 v[100:103], v5 offset:40960
    ds_read_b128 v[104:107], v6 offset:0
    ds_read_b128 v[108:111], v6 offset:20480
    v_max3_u32 v166, v64, v65, v166
    v_max3_u32 v166, v66, v67, v166
    s_waitcnt vmcnt(6) lgkmcnt(9)
    v_mfma_f32_16x16x32_bf16 v[32:35], v[112:115], v[68:71], v[32:35]
    v_mfma_f32_16x16x32_bf16 v[36:39], v[116:119], v[68:71], v[36:39]
    v_mfma_f32_16x16x32_bf16 v[40:43], v[120:123], v[68:71], v[40:43]
    v_mfma_f32_16x16x32_bf16 v[44:47], v[124:127], v[68:71], v[44:47]
    v_mfma_f32_16x16x32_bf16 v[48:51], v[128:131], v[68:71], v[48:51]
    ds_read_b128 v[116:119], v5 offset:21504
    ds_read_b128 v[120:123], v5 offset:41984
    ds_read_b128 v[124:127], v6 offset:1024
    ds_read_b128 v[128:131], v6 offset:21504
    v_max3_u32 v166, v68, v69, v166
    v_max3_u32 v166, v70, v71, v166
    s_waitcnt vmcnt(4) lgkmcnt(8)
    v_mfma_f32_16x16x32_bf16 v[32:35], v[132:135], v[72:75], v[32:35]
    v_mfma_f32_16x16x32_bf16 v[36:39], v[136:139], v[72:75], v[36:39]
    v_mfma_f32_16x16x32_bf16 v[40:43], v[140:143], v[72:75], v[40:43]
    v_mfma_f32_16x16x32_bf16 v[44:47], v[144:147], v[72:75], v[44:47]
    v_mfma_f32_16x16x32_bf16 v[48:51], v[148:151], v[72:75], v[48:51]
    ds_read_b128 v[136:139], v5 offset:22528
    ds_read_b128 v[140:143], v5 offset:43008
    ds_read_b128 v[144:147], v6 offset:2048
    ds_read_b128 v[148:151], v6 offset:22528
    v_max3_u32 v166, v72, v73, v166
    v_max3_u32 v166, v74, v75, v166
    s_waitcnt vmcnt(3) lgkmcnt(8)
    v_mfma_f32_16x16x32_bf16 v[32:35], v[16:19], v[76:79], v[32:35]
    v_mfma_f32_16x16x32_bf16 v[36:39], v[96:99], v[76:79], v[36:39]
    v_mfma_f32_16x16x32_bf16 v[40:43], v[100:103], v[76:79], v[40:43]
    v_mfma_f32_16x16x32_bf16 v[44:47], v[104:107], v[76:79], v[44:47]
    v_mfma_f32_16x16x32_bf16 v[48:51], v[108:111], v[76:79], v[48:51]
    ds_read_b128 v[96:99], v5 offset:23552
    ds_read_b128 v[100:103], v5 offset:44032
    ds_read_b128 v[104:107], v6 offset:3072
    ds_read_b128 v[108:111], v6 offset:23552
    v_max3_u32 v166, v76, v77, v166
    v_max3_u32 v166, v78, v79, v166
    s_waitcnt vmcnt(2) lgkmcnt(8)
    v_mfma_f32_16x16x32_bf16 v[32:35], v[20:23], v[80:83], v[32:35]
    v_mfma_f32_16x16x32_bf16 v[36:39], v[116:119], v[80:83], v[36:39]
    v_mfma_f32_16x16x32_bf16 v[40:43], v[120:123], v[80:83], v[40:43]
    v_mfma_f32_16x16x32_bf16 v[44:47], v[124:127], v[80:83], v[44:47]
    v_mfma_f32_16x16x32_bf16 v[48:51], v[128:131], v[80:83], v[48:51]
    v_max3_u32 v166, v80, v81, v166
    v_max3_u32 v166, v82, v83, v166
    s_waitcnt vmcnt(1) lgkmcnt(4)
    v_mfma_f32_16x16x32_bf16 v[32:35], v[24:27], v[84:87], v[32:35]
    v_mfma_f32_16x16x32_bf16 v[36:39], v[136:139], v[84:87], v[36:39]
    v_mfma_f32_16x16x32_bf16 v[40:43], v[140:143], v[84:87], v[40:43]
    v_mfma_f32_16x16x32_bf16 v[44:47], v[144:147], v[84:87], v[44:47]
    v_mfma_f32_16x16x32_bf16 v[48:51], v[148:151], v[84:87], v[48:51]
    v_max3_u32 v166, v84, v85, v166
    v_max3_u32 v166, v86, v87, v166
    s_waitcnt vmcnt(0) lgkmcnt(0)
    v_mfma_f32_16x16x32_bf16 v[32:35], v[28:31], v[88:91], v[32:35]
    v_mfma_f32_16x16x32_bf16 v[36:39], v[96:99], v[88:91], v[36:39]
    v_mfma_f32_16x16x32_bf16 v[40:43], v[100:103], v[88:91], v[40:43]
    v_mfma_f32_16x16x32_bf16 v[44:47], v[104:107], v[88:91], v[44:47]
    v_mfma_f32_16x16x32_bf16 v[48:51], v[108:111], v[88:91], v[48:51]
    v_max3_u32 v166, v88, v89, v166
    v_max3_u32 v166, v90, v91, v166
    v_cmp_eq_u32 vcc, -1, v166
    s_add_u32 s69, s69, 1
    s_cmp_gt_u32 s69, 0x4000
    s_cbranch_vccz K3_VALID
    s_cbranch_scc1 K3_VALID
    s_add_u32 s53, s52, 10240
    buffer_load_dwordx4 v[52:55], v7, s[8:11], s53 offen sc1
    s_add_u32 s53, s52, 12800
    buffer_load_dwordx4 v[56:59], v7, s[8:11], s53 offen sc1
    s_add_u32 s53, s52, 15360
    buffer_load_dwordx4 v[60:63], v7, s[8:11], s53 offen sc1
    s_add_u32 s53, s52, 17920
    buffer_load_dwordx4 v[64:67], v7, s[8:11], s53 offen sc1
    s_add_u32 s53, s52, 0
    buffer_load_dwordx2 v[68:69], v8, s[8:11], s53 offen sc1
    buffer_load_dwordx2 v[70:71], v8, s[8:11], s53 offen offset:1280 sc1
    s_add_u32 s53, s52, 10240
    buffer_load_dwordx2 v[72:73], v8, s[8:11], s53 offen sc1
    buffer_load_dwordx2 v[74:75], v8, s[8:11], s53 offen offset:1280 sc1
    s_add_u32 s53, s52, 0
    buffer_load_dwordx4 v[76:79], v7, s[8:11], s53 offen sc1
    s_add_u32 s53, s52, 2560
    buffer_load_dwordx4 v[80:83], v7, s[8:11], s53 offen sc1
    s_add_u32 s53, s52, 5120
    buffer_load_dwordx4 v[84:87], v7, s[8:11], s53 offen sc1
    s_add_u32 s53, s52, 7680
    buffer_load_dwordx4 v[88:91], v7, s[8:11], s53 offen sc1
    s_branch K3_RETRY
K3_VALID:
    s_cmp_eq_u32 s68, 1
    s_cbranch_scc1 K2_HAVEY
    s_lshl_b32 s56, s20, 1
    s_lshr_b32 s57, s23, 1
    s_add_u32 s56, s56, s57
    s_lshr_b32 s57, s56, 2
    s_lshl_b32 s57, s57, 6
    s_and_b32 s56, s56, 3
    s_lshl_b32 s56, s56, 3
    s_add_u32 s56, s56, s57
    v_and_b32 v132, 3, v0
    v_bfe_u32 v136, v0, 2, 1
    v_lshl_add_u32 v132, v136, 5, v132
    v_bfe_u32 v136, v0, 3, 1
    v_lshl_add_u32 v132, v136, 2, v132
    v_add_u32 v132, s56, v132
    v_mov_b32 v133, v132
    s_and_b32 s57, s23, 1
    s_cmp_eq_u32 s57, 0
    s_cbranch_scc1 TOK132_D
    v_cmp_eq_u32 vcc, 0, v132
    v_mov_b32 v136, 1024
    s_nop 0
    v_cndmask_b32 v132, v132, v136, vcc
    v_sub_u32 v133, 2048, v132
TOK132_D:
    v_lshrrev_b32 v129, 4, v0
    s_mul_i32 s58, s21, 80
    s_mul_i32 s59, s24, 48
    s_add_u32 s58, s58, s59
    v_lshl_add_u32 v128, v129, 2, s58
    s_movk_i32 s59, 1408
    v_mul_u32_u24 v132, s59, v132
    v_sub_u32 v129, 605, v128
    s_cmp_ge_u32 s21, 4
    s_cselect_b64 s[64:65], -1, 0
    s_cselect_b32 s58, 1, 0
    s_xor_b32 s58, s58, s57
    s_mul_i32 s58, s58, 1572864
    s_add_u32 s58, s58, 13893632
    v_cndmask_b32 v129, v128, v129, s[64:65]
    v_lshl_add_u32 v132, v129, 2, v132
    v_add_u32 v132, s58, v132
    v_lshlrev_b32 v133, 2, v133
    s_mov_b32 s66, 8716288
    buffer_load_dword v164, v133, s[8:11], s66 offen
    buffer_load_dwordx4 v[152:155], v132, s[8:11], 0 offen offset:0 sc1
    buffer_load_dwordx4 v[156:159], v132, s[8:11], 0 offen offset:64 sc1
    buffer_load_dwordx4 v[160:163], v132, s[8:11], 0 offen offset:128 sc1
    s_waitcnt vmcnt(3)
K2_HAVEY:
    s_mul_i32 s56, s22, 3072
    s_add_u32 s56, s56, 13312
    v_add_u32 v9, s56, v3
    s_xor_b32 s57, s22, 4
    s_mul_i32 s57, s57, 3072
    s_add_u32 s57, s57, 13312
    v_add_u32 v10, s57, v3
    s_nop 1
    s_cmp_eq_u32 s24, 0
    s_cbranch_scc0 K3_X1
    ds_write_b128 v9, v[44:47] offset:0
    ds_write_b128 v9, v[48:51] offset:1024
    s_branch K3_X2
K3_X1:
    ds_write_b128 v9, v[32:35] offset:0
    ds_write_b128 v9, v[36:39] offset:1024
    ds_write_b128 v9, v[40:43] offset:2048
    s_nop 4
    v_mov_b32 v32, v44
    v_mov_b32 v33, v45
    v_mov_b32 v34, v46
    v_mov_b32 v35, v47
    v_mov_b32 v36, v48
    v_mov_b32 v37, v49
    v_mov_b32 v38, v50
    v_mov_b32 v39, v51
K3_X2:
    v_mul_f32 v164, 0xbfb8aa3b, v164
    v_exp_f32 v164, v164
    s_nop 0
    v_add_f32 v164, 1.0, v164
    v_rcp_f32 v164, v164
    s_nop 0
    v_sub_f32 v165, 1.0, v164
    s_waitcnt lgkmcnt(0)
    s_barrier
    ds_read_b128 v[52:55], v10 offset:0
    ds_read_b128 v[56:59], v10 offset:1024
    ds_read_b128 v[60:63], v10 offset:2048
    s_waitcnt lgkmcnt(0)
    v_add_f32 v32, v32, v52
    v_add_f32 v33, v33, v53
    v_add_f32 v34, v34, v54
    v_add_f32 v35, v35, v55
    v_add_f32 v36, v36, v56
    v_add_f32 v37, v37, v57
    v_add_f32 v38, v38, v58
    v_add_f32 v39, v39, v59
    v_add_f32 v40, v40, v60
    v_add_f32 v41, v41, v61
    v_add_f32 v42, v42, v62
    v_add_f32 v43, v43, v63
    v_mul_f32 v32, v32, v165
    v_mul_f32 v33, v33, v165
    v_mul_f32 v34, v34, v165
    v_mul_f32 v35, v35, v165
    v_mul_f32 v36, v36, v165
    v_mul_f32 v37, v37, v165
    v_mul_f32 v38, v38, v165
    v_mul_f32 v39, v39, v165
    v_mul_f32 v40, v40, v165
    v_mul_f32 v41, v41, v165
    v_mul_f32 v42, v42, v165
    v_mul_f32 v43, v43, v165
    s_cmp_ge_u32 s21, 4
    s_waitcnt vmcnt(0)
    s_cbranch_scc1 K3_REV
    v_fmac_f32 v32, v152, v164
    v_fmac_f32 v33, v153, v164
    v_fmac_f32 v34, v154, v164
    v_fmac_f32 v35, v155, v164
    v_fmac_f32 v36, v156, v164
    v_fmac_f32 v37, v157, v164
    v_fmac_f32 v38, v158, v164
    v_fmac_f32 v39, v159, v164
    v_fmac_f32 v40, v160, v164
    v_fmac_f32 v41, v161, v164
    v_fmac_f32 v42, v162, v164
    v_fmac_f32 v43, v163, v164
    s_branch K3_ST
K3_REV:
    v_fmac_f32 v32, v163, v164
    v_fmac_f32 v33, v162, v164
    v_fmac_f32 v34, v161, v164
    v_fmac_f32 v35, v160, v164
    v_fmac_f32 v36, v159, v164
    v_fmac_f32 v37, v158, v164
    v_fmac_f32 v38, v157, v164
    v_fmac_f32 v39, v156, v164
    v_fmac_f32 v40, v155, v164
    v_fmac_f32 v41, v154, v164
    v_fmac_f32 v42, v153, v164
    v_fmac_f32 v43, v152, v164
K3_ST:
    v_cvt_pk_bf16_f32 v16, v32, v33
    v_cvt_pk_bf16_f32 v17, v34, v35
    v_cvt_pk_bf16_f32 v18, v36, v37
    v_cvt_pk_bf16_f32 v19, v38, v39
    v_cvt_pk_bf16_f32 v20, v40, v41
    v_cvt_pk_bf16_f32 v21, v42, v43
    buffer_store_dwordx2 v[16:17], v11, s[12:15], 0 offen
    buffer_store_dwordx2 v[18:19], v11, s[12:15], 0 offen offset:32
    s_cmp_eq_u32 s24, 0
    s_cbranch_scc0 K3_DONE
    buffer_store_dwordx2 v[20:21], v11, s[12:15], 0 offen offset:64
K3_DONE:
    s_endpgm
K2_SLOW:
    s_cmp_eq_u32 s24, 0
    s_cbranch_scc1 K2_SL0
    v_mov_b32 v96, v100
    v_mov_b32 v97, v101
    v_mov_b32 v98, v102
    v_mov_b32 v99, v103
    v_mov_b32 v104, v106
    v_mov_b32 v105, v107
K2_SL0:
    v_cndmask_b32 v104, 0, v104, s[50:51]
    v_cndmask_b32 v105, 0, v105, s[50:51]
    v_mov_b32 v128, 0xff800000
    v_mov_b32 v129, 0x3f803f80
    v_mul_u32_u24 v130, 336, v2
    v_lshl_add_u32 v130, v1, 4, v130
    v_add_u32 v130, 1280, v130
    s_mov_b32 s56, s27
    s_mov_b32 s57, 0
K2_SL1:
    buffer_load_dwordx4 v[108:111], v3, s[8:11], s56 offen
    buffer_load_dwordx2 v[112:113], v4, s[8:11], s56 offen offset:1024
    s_waitcnt vmcnt(0)
    v_mfma_f32_32x32x8_bf16 v[16:31], v[112:113], v[104:105], 0
    v_mfma_f32_32x32x16_bf16 v[16:31], v[108:111], v[96:99], v[16:31]
    s_nop 15
    s_nop 3
    v_max3_f32 v128, v16, v17, v128
    v_max3_f32 v128, v18, v19, v128
    v_max3_f32 v128, v20, v21, v128
    v_max3_f32 v128, v22, v23, v128
    v_max3_f32 v128, v24, v25, v128
    v_max3_f32 v128, v26, v27, v128
    v_max3_f32 v128, v28, v29, v128
    v_max3_f32 v128, v30, v31, v128
    s_add_u32 s56, s56, 2688
    s_add_u32 s57, s57, 1
    s_cmp_lt_u32 s57, 64
    s_cbranch_scc1 K2_SL1
    v_mov_b32 v131, v128
    s_nop 1
    v_permlane32_swap_b32 v128, v131
    s_nop 1
    v_max_f32 v128, v128, v131
    v_mul_f32 v128, -1.0, v128
    v_and_b32 v132, 0xffff0000, v128
    v_sub_f32 v133, v128, v132
    v_and_b32 v134, 0xffff0000, v133
    v_sub_f32 v135, v133, v134
    v_lshrrev_b32 v132, 16, v132
    v_or_b32 v132, v132, v134
    v_lshrrev_b32 v135, 16, v135
    v_cndmask_b32 v104, v132, v104, s[50:51]
    v_cndmask_b32 v105, v135, v105, s[50:51]
    v_mov_b32 v64, 0
    v_mov_b32 v65, 0
    v_mov_b32 v66, 0
    v_mov_b32 v67, 0
    v_mov_b32 v68, 0
    v_mov_b32 v69, 0
    v_mov_b32 v70, 0
    v_mov_b32 v71, 0
    v_mov_b32 v72, 0
    v_mov_b32 v73, 0
    v_mov_b32 v74, 0
    v_mov_b32 v75, 0
    v_mov_b32 v76, 0
    v_mov_b32 v77, 0
    v_mov_b32 v78, 0
    v_mov_b32 v79, 0
    s_mov_b32 s57, 0
K2_SL2:
    s_add_u32 s58, s57, 62
    s_and_b32 s58, s58, 63
    s_mul_i32 s58, s58, 2688
    s_add_u32 s58, s58, s27
    s_mul_i32 s56, s57, 2688
    s_add_u32 s56, s56, s27
    buffer_load_dwordx4 v[108:111], v3, s[8:11], s58 offen
    buffer_load_dwordx2 v[112:113], v4, s[8:11], s58 offen offset:1024
    buffer_load_dwordx4 v[116:119], v130, s[8:11], s56 offen
    buffer_load_dwordx4 v[120:123], v130, s[8:11], s56 offen offset:672
    s_waitcnt vmcnt(0)
    v_cndmask_b32 v112, v129, v112, s[50:51]
    v_cndmask_b32 v113, v129, v113, s[50:51]
    s_nop 1
    v_mfma_f32_32x32x8_bf16 v[16:31], v[112:113], v[104:105], 0
    v_mfma_f32_32x32x16_bf16 v[16:31], v[108:111], v[96:99], v[16:31]
    s_nop 15
    s_nop 3
    v_exp_f32 v16, v16
    v_exp_f32 v17, v17
    v_exp_f32 v18, v18
    v_exp_f32 v19, v19
    v_cvt_pk_bf16_f32 v48, v16, v17
    v_cvt_pk_bf16_f32 v49, v18, v19
    v_exp_f32 v20, v20
    v_exp_f32 v21, v21
    v_exp_f32 v22, v22
    v_exp_f32 v23, v23
    v_cvt_pk_bf16_f32 v50, v20, v21
    v_cvt_pk_bf16_f32 v51, v22, v23
    v_exp_f32 v24, v24
    v_exp_f32 v25, v25
    v_exp_f32 v26, v26
    v_exp_f32 v27, v27
    v_cvt_pk_bf16_f32 v52, v24, v25
    v_cvt_pk_bf16_f32 v53, v26, v27
    v_exp_f32 v28, v28
    v_exp_f32 v29, v29
    v_exp_f32 v30, v30
    v_exp_f32 v31, v31
    v_cvt_pk_bf16_f32 v54, v28, v29
    v_cvt_pk_bf16_f32 v55, v30, v31
    s_nop 1
    v_mfma_f32_32x32x16_bf16 v[64:79], v[116:119], v[48:51], v[64:79]
    v_mfma_f32_32x32x16_bf16 v[64:79], v[120:123], v[52:55], v[64:79]
    s_add_u32 s57, s57, 1
    s_cmp_lt_u32 s57, 64
    s_cbranch_scc1 K2_SL2
    s_nop 15
    s_nop 3
    v_mov_b32 v28, v72
    v_mov_b32 v29, v72
    s_nop 1
    v_permlane32_swap_b32 v28, v29
    s_nop 1
    v_rcp_f32 v29, v29
    s_nop 0
    s_branch K2_FINAL
K2_AUX:
    s_sub_u32 s22, s22, 8
    s_mul_i32 s46, s22, 5120
    v_add_u32 v6, s46, v3
    v_add_u32 v7, 4096, v6
    s_mov_b32 m0, s46
    s_waitcnt lgkmcnt(0)
    s_mov_b32 s8, s4
    s_and_b32 s9, s5, 0xffff
    s_cmp_eq_u32 s22, 0
    s_cbranch_scc0 K2_P0Y
    s_getreg_b32 s60, hwreg(HW_REG_XCC_ID, 0, 4)
    s_add_u32 s60, s60, 1
    s_lshl_b32 s63, s18, 9
    s_add_u32 s63, s63, 8699904
    v_lshlrev_b32 v9, 4, v1
    v_lshl_add_u32 v17, v2, 12, v9
    v_mov_b32 v10, s60
    v_mov_b32 v11, 127
    v_cmp_gt_u32 vcc, 32, v0
    s_mov_b32 s39, 0
    s_nop 0
    v_cndmask_b32 v10, v11, v10, vcc
    s_lshl_b32 s30, s18, 12
    s_and_b32 s31, s16, 3
    s_lshl_b32 s31, s31, 4
    s_add_u32 s30, s30, s31
    s_add_u32 s30, s30, 8650752
    v_lshlrev_b32 v16, 7, v1
    v_mov_b32 v24, 64560
    v_mov_b32 v25, -1
    s_barrier
    ds_write_b32 v24, v25
K2_P0S:
    s_mov_b32 s39, 0
    s_mov_b32 s38, 0
K2_P0:
    buffer_load_dwordx4 v[12:15], v9, s[8:11], s63 offen sc1
    s_add_u32 s39, s39, 1
    s_waitcnt vmcnt(0)
    v_xor_b32 v12, v12, v10
    v_xor_b32 v13, v13, v10
    v_xor_b32 v14, v14, v10
    v_xor_b32 v15, v15, v10
    v_or3_b32 v12, v12, v13, v14
    v_or_b32 v12, v12, v15
    v_cmp_eq_u32 vcc, 0, v12
    s_cmp_gt_u32 s39, 0x10000
    s_cbranch_scc1 K2_P0K
    s_cmp_eq_u32 vcc_lo, -1
    s_cbranch_scc1 K2_P0K
    s_or_b32 s62, vcc_lo, vcc_hi
    s_cmp_eq_u32 s62, -1
    s_cselect_b32 s62, s38, 0
    s_cmp_eq_u32 s62, 1
    s_cbranch_scc1 K2_P0K
    s_cmp_eq_u32 s38, 1
    s_cbranch_scc1 K2_P0
    s_cmp_ge_u32 s39, 96
    s_cbranch_scc0 K2_P0
    s_mov_b32 s38, 1
    v_mov_b32 v9, v17
    buffer_wbl2 sc1
    s_lshl_b32 s60, s18, 9
    s_lshl_b32 s61, s19, 4
    s_add_u32 s60, s60, s61
    s_add_u32 s60, s60, 8704000
    v_mov_b32 v8, 0
    v_mov_b32 v12, 127
    v_mov_b32 v13, 127
    v_mov_b32 v14, 127
    v_mov_b32 v15, 127
    s_waitcnt vmcnt(0)
    s_mov_b64 exec, 1
    buffer_store_dwordx4 v[12:15], v8, s[8:11], s60 offen sc1
    s_mov_b64 exec, -1
    s_branch K2_P0
K2_P0K:
    s_cmp_eq_u32 s38, 0
    s_cbranch_scc1 K2_P0L
    buffer_inv sc1
    s_waitcnt vmcnt(0)
K2_P0L:
    buffer_load_dwordx4 v[20:23], v16, s[8:11], s30 offen sc1
    s_waitcnt lgkmcnt(0)
    s_branch K2_P0X
K2_P0Y:
    s_barrier
K2_P0X:
    s_setprio 3
    s_barrier
    buffer_load_dwordx4 v6, s[8:11], s27 offen offset:0 sc1 lds
    buffer_load_dwordx4 v6, s[8:11], s27 offen offset:1024 sc1 lds
    buffer_load_dwordx4 v6, s[8:11], s27 offen offset:2048 sc1 lds
    buffer_load_dwordx4 v6, s[8:11], s27 offen offset:3072 sc1 lds
    s_add_u32 m0, m0, 4096
    s_cmp_eq_u32 s22, 3
    buffer_load_dwordx4 v7, s[8:11], s27 offen sc1 lds
    s_cbranch_scc0 K2_A0
    buffer_load_dwordx4 v7, s[8:11], s27 offen offset:1024 sc1 lds
K2_A0:
    s_cmp_eq_u32 s22, 0
    s_cbranch_scc0 K2_A1
    s_waitcnt vmcnt(5)
    v_max_f32_dpp v20, v20, v20 row_ror:1 row_mask:0xf bank_mask:0xf
    v_max_f32_dpp v21, v21, v21 row_ror:1 row_mask:0xf bank_mask:0xf
    v_max_f32_dpp v22, v22, v22 row_ror:1 row_mask:0xf bank_mask:0xf
    v_max_f32_dpp v20, v20, v20 row_ror:2 row_mask:0xf bank_mask:0xf
    v_max_f32_dpp v21, v21, v21 row_ror:2 row_mask:0xf bank_mask:0xf
    v_max_f32_dpp v22, v22, v22 row_ror:2 row_mask:0xf bank_mask:0xf
    v_max_f32_dpp v20, v20, v20 row_ror:4 row_mask:0xf bank_mask:0xf
    v_max_f32_dpp v21, v21, v21 row_ror:4 row_mask:0xf bank_mask:0xf
    v_max_f32_dpp v22, v22, v22 row_ror:4 row_mask:0xf bank_mask:0xf
    v_max_f32_dpp v20, v20, v20 row_ror:8 row_mask:0xf bank_mask:0xf
    v_max_f32_dpp v21, v21, v21 row_ror:8 row_mask:0xf bank_mask:0xf
    v_max_f32_dpp v22, v22, v22 row_ror:8 row_mask:0xf bank_mask:0xf
    v_max_f32_dpp v20, v20, v20 row_bcast:15 row_mask:0xa bank_mask:0xf
    v_max_f32_dpp v21, v21, v21 row_bcast:15 row_mask:0xa bank_mask:0xf
    v_max_f32_dpp v22, v22, v22 row_bcast:15 row_mask:0xa bank_mask:0xf
    v_add_f32 v20, v20, v21
    v_add_f32 v20, v20, v22
    v_min_u32 v20, -2, v20
    s_mov_b32 exec_lo, 0x80000000
    s_mov_b32 exec_hi, 0
    ds_write_b32 v24, v20
    s_mov_b64 exec, -1
K2_A1:
    s_setprio 0
    s_mul_i32 s47, s21, 102400
    s_add_u32 s47, s47, 10354688
    s_lshl_b32 s33, s22, 2
    s_add_u32 s33, s33, 64544
    v_mov_b32 v6, s33
    v_and_b32 v7, 3, v0
    v_lshlrev_b32 v7, 2, v7
    v_add_u32 v7, 64544, v7
    v_mov_b32 v146, 0
    ds_write_b32 v6, v146
    s_cmp_eq_u32 s22, 1
    s_cbranch_scc1 K2_WOTW
    s_cmp_ge_u32 s22, 2
    s_cbranch_scc1 K2_FNW
    v_and_b32 v7, 7, v0
    v_lshlrev_b32 v7, 2, v7
    v_add_u32 v7, 64512, v7
    s_add_u32 s41, s27, 21504
    s_mov_b32 s40, 21504
    s_mov_b32 s42, 1
    s_waitcnt vmcnt(0) lgkmcnt(0)
    s_barrier
K2_LDLOOP:
    s_cmp_lt_u32 s42, 3
    s_cbranch_scc1 K2_LDGO
    s_sub_u32 s43, s42, 1
K2_LDSPIN:
    ds_read_b32 v147, v7
    s_waitcnt lgkmcnt(0)
    v_cmp_le_u32 vcc, s43, v147
    s_nop 0
    s_cmp_eq_u64 vcc, exec
    s_cbranch_scc1 K2_LDGO
    s_sleep 2
    s_branch K2_LDSPIN
K2_LDGO:
    s_mov_b32 s44, s41
    s_mov_b32 m0, s40
    s_nop 0
    buffer_load_dwordx4 v3, s[8:11], s44 offen offset:0 sc1 lds
    buffer_load_dwordx4 v3, s[8:11], s44 offen offset:1024 sc1 lds
    buffer_load_dwordx4 v3, s[8:11], s44 offen offset:2048 sc1 lds
    buffer_load_dwordx4 v3, s[8:11], s44 offen offset:3072 sc1 lds
    s_add_u32 m0, m0, 4096
    s_add_u32 s44, s44, 4096
    buffer_load_dwordx4 v3, s[8:11], s44 offen offset:0 sc1 lds
    buffer_load_dwordx4 v3, s[8:11], s44 offen offset:1024 sc1 lds
    buffer_load_dwordx4 v3, s[8:11], s44 offen offset:2048 sc1 lds
    buffer_load_dwordx4 v3, s[8:11], s44 offen offset:3072 sc1 lds
    s_add_u32 m0, m0, 4096
    s_add_u32 s44, s44, 4096
    buffer_load_dwordx4 v3, s[8:11], s44 offen offset:0 sc1 lds
    buffer_load_dwordx4 v3, s[8:11], s44 offen offset:1024 sc1 lds
    buffer_load_dwordx4 v3, s[8:11], s44 offen offset:2048 sc1 lds
    buffer_load_dwordx4 v3, s[8:11], s44 offen offset:3072 sc1 lds
    s_add_u32 m0, m0, 4096
    s_add_u32 s44, s44, 4096
    buffer_load_dwordx4 v3, s[8:11], s44 offen offset:0 sc1 lds
    buffer_load_dwordx4 v3, s[8:11], s44 offen offset:1024 sc1 lds
    buffer_load_dwordx4 v3, s[8:11], s44 offen offset:2048 sc1 lds
    buffer_load_dwordx4 v3, s[8:11], s44 offen offset:3072 sc1 lds
    s_add_u32 m0, m0, 4096
    s_add_u32 s44, s44, 4096
    buffer_load_dwordx4 v3, s[8:11], s44 offen offset:0 sc1 lds
    buffer_load_dwordx4 v3, s[8:11], s44 offen offset:1024 sc1 lds
    buffer_load_dwordx4 v3, s[8:11], s44 offen offset:2048 sc1 lds
    buffer_load_dwordx4 v3, s[8:11], s44 offen offset:3072 sc1 lds
    s_add_u32 m0, m0, 4096
    s_add_u32 s44, s44, 4096
    buffer_load_dwordx4 v3, s[8:11], s44 offen offset:0 sc1 lds
    s_add_u32 s41, s41, 21504
    s_add_u32 s40, s40, 21504
    s_cmp_eq_u32 s40, 64512
    s_cselect_b32 s40, 0, s40
    s_add_u32 s42, s42, 1
    v_mov_b32 v146, s42
    s_waitcnt vmcnt(0)
    ds_write_b32 v6, v146
    s_cmp_lt_u32 s42, 8
    s_cbranch_scc1 K2_LDLOOP
K2_LDFIN:
    ds_read_b32 v147, v7
    s_waitcnt lgkmcnt(0)
    v_cmp_le_u32 vcc, 8, v147
    s_nop 0
    s_cmp_eq_u64 vcc, exec
    s_cbranch_scc1 K2_LDFIN_X
    s_sleep 2
    s_branch K2_LDFIN
K2_LDFIN_X:
    v_mov_b32 v146, 9
    ds_write_b32 v6, v146
    s_mul_i32 s34, s20, 81920
    s_add_u32 s34, s34, 11273468
    v_mul_u32_u24 v4, 1280, v0
    v_add_u32 v4, s34, v4
    s_mov_b32 s39, 0
K2_LDF2:
    s_sleep 2
    ds_read_b32 v147, v7
    s_waitcnt lgkmcnt(0)
    v_cmp_le_u32 vcc, 10, v147
    s_nop 0
    s_cmp_eq_u64 vcc, exec
    s_cbranch_scc0 K2_LDF2
K2_POLL:
    s_sleep 4
    buffer_load_dword v12, v4, s[8:11], 0 offen sc1
    s_add_u32 s39, s39, 1
    s_waitcnt vmcnt(0)
    v_cmp_eq_u32 vcc, -1, v12
    s_cmp_gt_u32 s39, 0x8000
    s_cbranch_scc1 K2_POLL_X
    s_cbranch_vccnz K2_POLL
K2_POLL_X:
    s_barrier
    s_branch K2_AUXEND
K2_WOTW:
    v_and_b32 v7, 1, v0
    v_lshlrev_b32 v7, 2, v7
    v_add_u32 v7, 64552, v7
    v_mov_b32 v13, 64544
    s_waitcnt vmcnt(0) lgkmcnt(0)
    s_barrier
K2_WWAIT:
    s_sleep 16
    ds_read_b32 v14, v13
    s_waitcnt lgkmcnt(0)
    v_cmp_le_u32 vcc, 6, v14
    s_nop 1
    s_cbranch_vccz K2_WWAIT
    s_lshl_b32 s39, s18, 10
    s_add_u32 s39, s39, 8732672
    v_add_u32 v8, s39, v3
    s_mov_b32 s39, 0
K2_XW1:
    buffer_load_dwordx4 v[16:19], v8, s[8:11], 0 offen sc1
    s_add_u32 s39, s39, 1
    s_waitcnt vmcnt(0)
    v_and_b32 v16, v16, v17
    v_and_b32 v18, v18, v19
    v_and_b32 v16, v16, v18
    v_cmp_ne_u32 vcc, 1, v16
    s_cmp_gt_u32 s39, 0x8000
    s_cbranch_scc1 K2_XW1_X
    s_cbranch_vccz K2_XW1_X
    s_sleep 8
    s_branch K2_XW1
K2_XW1_X:
    v_mov_b32 v146, 1
    ds_write_b32 v6, v146
    s_add_u32 s57, s47, 36864
    s_mov_b32 s58, 98304
    s_mov_b32 s59, 16
K2_WLOOP:
    s_mov_b32 m0, s58
    s_add_u32 s58, s58, 4096
    buffer_load_dwordx4 v3, s[8:11], s57 offen offset:0 lds
    buffer_load_dwordx4 v3, s[8:11], s57 offen offset:1024 lds
    buffer_load_dwordx4 v3, s[8:11], s57 offen offset:2048 lds
    buffer_load_dwordx4 v3, s[8:11], s57 offen offset:3072 lds
    s_add_u32 s57, s57, 4096
    s_sub_u32 s59, s59, 1
    s_waitcnt vmcnt(4)
    s_cmp_lg_u32 s59, 0
    s_cbranch_scc1 K2_WLOOP
K2_WSPIN:
    ds_read_b32 v147, v7
    s_waitcnt lgkmcnt(0)
    v_cmp_le_u32 vcc, 2, v147
    s_nop 0
    s_cmp_eq_u64 vcc, exec
    s_cbranch_scc1 K2_WLATE
    s_sleep 8
    s_branch K2_WSPIN
K2_WLATE:
    s_add_u32 s57, s47, 4096
    s_mov_b32 s58, 65536
    s_mov_b32 s59, 8
K2_WLOOP2:
    s_mov_b32 m0, s58
    s_add_u32 s58, s58, 4096
    buffer_load_dwordx4 v3, s[8:11], s57 offen lds
    buffer_load_dwordx4 v3, s[8:11], s57 offen offset:1024 lds
    buffer_load_dwordx4 v3, s[8:11], s57 offen offset:2048 lds
    buffer_load_dwordx4 v3, s[8:11], s57 offen offset:3072 lds
    s_add_u32 s57, s57, 4096
    s_sub_u32 s59, s59, 1
    s_cmp_lg_u32 s59, 0
    s_cbranch_scc1 K2_WLOOP2
K2_WDONE:
    s_and_b32 s35, s20, 30
    s_cmp_eq_u32 s35, 0
    s_cselect_b32 s38, 32, s35
    s_mul_i32 s36, s21, 80
    s_sub_u32 s37, 561, s36
    s_cmp_lt_u32 s21, 4
    s_cselect_b32 s36, s36, s37
    s_lshr_b32 s36, s36, 6
    v_bfe_u32 v5, v0, 2, 2
    v_min_u32 v5, 2, v5
    v_bfe_u32 v9, v0, 4, 1
    v_add_u32 v5, s36, v5
    v_min_u32 v5, 5, v5
    v_add_u32 v9, s35, v9
    v_mov_b32 v10, s38
    v_cmp_lt_u32 vcc, 31, v0
    s_nop 1
    v_cndmask_b32 v9, v9, v10, vcc
    v_lshlrev_b32 v9, 7, v9
    v_lshl_add_u32 v5, v5, 4, v9
    v_and_b32 v9, 1, v0
    v_lshl_add_u32 v5, v9, 2, v5
    v_add_u32 v5, 8691712, v5
    s_mov_b32 s39, 0
K2_POLLY:
    buffer_load_dword v12, v5, s[8:11], 0 offen sc1
    s_add_u32 s39, s39, 1
    s_waitcnt vmcnt(0)
    v_cmp_eq_u32 vcc, 1, v12
    s_cmp_gt_u32 s39, 0x20000
    s_cbranch_scc1 K2_POLLY_X
    s_cmp_eq_u64 vcc, exec
    s_cbranch_scc1 K2_POLLY_OK
    s_sleep 8
    s_branch K2_POLLY
K2_POLLY_OK:
    v_mov_b32 v146, 3
    ds_write_b32 v6, v146
K2_POLLY_X:
    s_waitcnt lgkmcnt(0)
    s_branch K2_AUXEND
K2_FNW:
    s_mul_i32 s25, s19, 43
    s_lshr_b32 s25, s25, 8
    s_mul_i32 s26, s25, 6
    s_sub_u32 s26, s19, s26
    s_lshl_b32 s23, s18, 2
    s_add_u32 s25, s25, s23
    s_cmp_lt_u32 s19, 24
    s_cbranch_scc1 KF_JOB
    s_mov_b32 s25, 32
    s_mov_b32 s26, s18
    s_cmp_gt_u32 s19, 24
    s_cbranch_scc1 KF_NOJOB
    s_cmp_ge_u32 s26, 6
    s_cbranch_scc1 KF_NOJOB
KF_JOB:
    s_sub_u32 s23, s22, 2
    s_mov_b32 s30, 8781824
    s_mov_b32 s31, 9568256
    s_cmp_eq_u32 s23, 0
    s_cselect_b32 s60, s52, s54
    s_cselect_b32 s61, s53, s55
    s_cselect_b32 s30, s30, s31
    s_and_b32 s61, s61, 0xffff
    s_mov_b32 s62, 8388608
    s_mov_b32 s63, 0x00020000
    s_lshl_b32 s28, s25, 5
    v_lshrrev_b32 v4, 3, v0
    v_add_u32 v4, s28, v4
    v_lshlrev_b32 v4, 12, v4
    v_and_b32 v5, 7, v0
    v_lshrrev_b32 v9, 4, v0
    v_xor_b32 v5, v5, v9
    v_lshl_add_u32 v8, v5, 4, v4
    v_xor_b32 v9, 64, v8
    v_add_u32 v9, 0x8000, v9
    v_add_u32 v10, 0x10000, v8
    v_add_u32 v11, 0x10000, v9
    s_lshl_b32 s33, s23, 14
    s_add_u32 s33, s33, 65536
    v_bfe_u32 v4, v1, 1, 3
    v_lshlrev_b32 v5, 2, v2
    v_lshl_add_u32 v160, v1, 7, s33
    v_add_u32 v161, 0, v5
    v_xor_b32 v161, v161, v4
    v_lshl_add_u32 v12, v161, 4, v160
    v_add_u32 v161, 1, v5
    v_xor_b32 v161, v161, v4
    v_lshl_add_u32 v13, v161, 4, v160
    v_add_u32 v161, 2, v5
    v_xor_b32 v161, v161, v4
    v_lshl_add_u32 v14, v161, 4, v160
    v_add_u32 v161, 3, v5
    v_xor_b32 v161, v161, v4
    v_lshl_add_u32 v15, v161, 4, v160
    s_mov_b32 s29, 0
    s_lshl_b32 s31, s26, 11
    s_add_u32 s30, s30, s31
    v_add_u32 v4, s28, v1
    v_lshlrev_b32 v5, 12, v4
    v_lshl_add_u32 v5, v2, 4, v5
    v_add_u32 v160, s33, v3
    v_and_b32 v64, 15, v0
    v_lshrrev_b32 v65, 4, v0
    s_lshl_b32 s34, s23, 4
    v_add_u32 v65, s34, v65
    v_lshrrev_b32 v66, 1, v64
    v_lshlrev_b32 v66, 10, v66
    v_and_b32 v67, 1, v64
    v_lshl_add_u32 v67, v67, 5, v65
    v_lshl_add_u32 v161, v67, 4, v66
    v_add_u32 v161, 65536, v161
    v_add_u32 v65, s28, v65
    s_movk_i32 s34, 1408
    v_mul_u32_u24 v162, s34, v65
    v_lshl_add_u32 v162, v64, 4, v162
    s_lshl_b32 s35, s26, 8
    s_add_u32 s36, s35, 15466496
    s_add_u32 s35, s35, 13893632
    s_mov_b32 s64, 0x00ff00ff
    s_cmp_eq_u32 s26, 5
    s_cselect_b32 s64, s64, -1
    s_cselect_b32 s32, s23, 0
    s_mov_b32 s65, s64
    v_and_b32 v7, 1, v0
    v_lshlrev_b32 v7, 2, v7
    v_add_u32 v7, 64552, v7
    v_mov_b32 v16, 0
    v_mov_b32 v17, 0
    v_mov_b32 v18, 0
    v_mov_b32 v19, 0
    v_mov_b32 v20, 0
    v_mov_b32 v21, 0
    v_mov_b32 v22, 0
    v_mov_b32 v23, 0
    v_mov_b32 v24, 0
    v_mov_b32 v25, 0
    v_mov_b32 v26, 0
    v_mov_b32 v27, 0
    v_mov_b32 v28, 0
    v_mov_b32 v29, 0
    v_mov_b32 v30, 0
    v_mov_b32 v31, 0
    v_mov_b32 v32, 0
    v_mov_b32 v33, 0
    v_mov_b32 v34, 0
    v_mov_b32 v35, 0
    v_mov_b32 v36, 0
    v_mov_b32 v37, 0
    v_mov_b32 v38, 0
    v_mov_b32 v39, 0
    v_mov_b32 v40, 0
    v_mov_b32 v41, 0
    v_mov_b32 v42, 0
    v_mov_b32 v43, 0
    v_mov_b32 v44, 0
    v_mov_b32 v45, 0
    v_mov_b32 v46, 0
    v_mov_b32 v47, 0
    s_waitcnt vmcnt(0) lgkmcnt(0)
    s_barrier
    s_cmp_eq_u32 s32, 1
    s_cbranch_scc1 KF_NO65
    buffer_load_dwordx4 v[164:167], v5, s[60:63], 0 offen offset:2048
    s_add_u32 m0, s33, 0
    s_nop 0
    buffer_load_dwordx4 v8, s[60:63], s29 offen lds
    s_add_u32 m0, s33, 1024
    s_nop 0
    buffer_load_dwordx4 v9, s[60:63], s29 offen lds
    s_add_u32 m0, s33, 2048
    s_nop 0
    buffer_load_dwordx4 v10, s[60:63], s29 offen lds
    s_add_u32 m0, s33, 3072
    s_nop 0
    buffer_load_dwordx4 v11, s[60:63], s29 offen lds
    s_add_u32 s29, s29, 128
    s_add_u32 m0, s33, 4096
    s_nop 0
    buffer_load_dwordx4 v8, s[60:63], s29 offen lds
    s_add_u32 m0, s33, 5120
    s_nop 0
    buffer_load_dwordx4 v9, s[60:63], s29 offen lds
    s_add_u32 m0, s33, 6144
    s_nop 0
    buffer_load_dwordx4 v10, s[60:63], s29 offen lds
    s_add_u32 m0, s33, 7168
    s_nop 0
    buffer_load_dwordx4 v11, s[60:63], s29 offen lds
    s_add_u32 s29, s29, 128
    s_add_u32 m0, s33, 8192
    s_nop 0
    buffer_load_dwordx4 v8, s[60:63], s29 offen lds
    s_add_u32 m0, s33, 9216
    s_nop 0
    buffer_load_dwordx4 v9, s[60:63], s29 offen lds
    s_add_u32 m0, s33, 10240
    s_nop 0
    buffer_load_dwordx4 v10, s[60:63], s29 offen lds
    s_add_u32 m0, s33, 11264
    s_nop 0
    buffer_load_dwordx4 v11, s[60:63], s29 offen lds
    s_add_u32 s29, s29, 128
    s_lshl_b32 s39, s18, 10
    s_add_u32 s39, s39, 8732672
    v_add_u32 v163, s39, v3
    s_mov_b32 s39, 0
K2_XW2:
    buffer_load_dwordx4 v[64:67], v163, s[8:11], 0 offen sc1
    s_add_u32 s39, s39, 1
    s_waitcnt vmcnt(0)
    v_and_b32 v64, v64, v65
    v_and_b32 v66, v66, v67
    v_and_b32 v64, v64, v66
    v_cmp_ne_u32 vcc, 1, v64
    s_cmp_gt_u32 s39, 0x8000
    s_cbranch_scc1 K2_XW2_X
    s_cbranch_vccz K2_XW2_X
    s_sleep 8
    s_branch K2_XW2
K2_XW2_X:
    buffer_load_dwordx4 v[64:67], v3, s[8:11], s30 offen
    buffer_load_dwordx4 v[68:71], v3, s[8:11], s30 offen offset:1024
    s_add_u32 s30, s30, 11264
    buffer_load_dwordx4 v[72:75], v3, s[8:11], s30 offen
    buffer_load_dwordx4 v[76:79], v3, s[8:11], s30 offen offset:1024
    s_add_u32 s30, s30, 11264
    buffer_load_dwordx4 v[80:83], v3, s[8:11], s30 offen
    buffer_load_dwordx4 v[84:87], v3, s[8:11], s30 offen offset:1024
    s_add_u32 s30, s30, 11264
    buffer_load_dwordx4 v[88:91], v3, s[8:11], s30 offen
    buffer_load_dwordx4 v[92:95], v3, s[8:11], s30 offen offset:1024
    s_add_u32 s30, s30, 11264
    buffer_load_dwordx4 v[96:99], v3, s[8:11], s30 offen
    buffer_load_dwordx4 v[100:103], v3, s[8:11], s30 offen offset:1024
    s_add_u32 s30, s30, 11264
    buffer_load_dwordx4 v[104:107], v3, s[8:11], s30 offen
    buffer_load_dwordx4 v[108:111], v3, s[8:11], s30 offen offset:1024
    s_add_u32 s30, s30, 11264
    buffer_load_dwordx4 v[112:115], v3, s[8:11], s30 offen
    buffer_load_dwordx4 v[116:119], v3, s[8:11], s30 offen offset:1024
    s_add_u32 s30, s30, 11264
    buffer_load_dwordx4 v[120:123], v3, s[8:11], s30 offen
    buffer_load_dwordx4 v[124:127], v3, s[8:11], s30 offen offset:1024
    s_add_u32 s30, s30, 11264
    buffer_load_dwordx4 v[128:131], v3, s[8:11], s30 offen
    buffer_load_dwordx4 v[132:135], v3, s[8:11], s30 offen offset:1024
    s_add_u32 s30, s30, 11264
    buffer_load_dwordx4 v[136:139], v3, s[8:11], s30 offen
    buffer_load_dwordx4 v[140:143], v3, s[8:11], s30 offen offset:1024
    s_add_u32 s30, s30, 11264
    buffer_load_dwordx4 v[144:147], v3, s[8:11], s30 offen
    buffer_load_dwordx4 v[148:151], v3, s[8:11], s30 offen offset:1024
    s_add_u32 s30, s30, 11264
    buffer_load_dwordx4 v[152:155], v3, s[8:11], s30 offen
    buffer_load_dwordx4 v[156:159], v3, s[8:11], s30 offen offset:1024
    s_add_u32 s30, s30, 11264
    s_waitcnt vmcnt(0)
    s_setprio 0
    s_mov_b32 s42, 0
KF_LOOP:
    s_waitcnt vmcnt(24)
    ds_read_b128 v[48:51], v12 offset:0
    ds_read_b128 v[52:55], v13 offset:0
    ds_read_b128 v[56:59], v14 offset:0
    ds_read_b128 v[60:63], v15 offset:0
    s_waitcnt lgkmcnt(3)
    v_mfma_f32_32x32x16_bf16 v[16:31], v[64:67], v[48:51], v[16:31]
    buffer_load_dwordx4 v[64:67], v3, s[8:11], s30 offen offset:0
    v_mfma_f32_32x32x16_bf16 v[32:47], v[68:71], v[48:51], v[32:47]
    buffer_load_dwordx4 v[68:71], v3, s[8:11], s30 offen offset:1024
    s_add_u32 s30, s30, 11264
    s_waitcnt lgkmcnt(2)
    v_mfma_f32_32x32x16_bf16 v[16:31], v[72:75], v[52:55], v[16:31]
    buffer_load_dwordx4 v[72:75], v3, s[8:11], s30 offen offset:0
    v_mfma_f32_32x32x16_bf16 v[32:47], v[76:79], v[52:55], v[32:47]
    buffer_load_dwordx4 v[76:79], v3, s[8:11], s30 offen offset:1024
    s_add_u32 s30, s30, 11264
    s_waitcnt lgkmcnt(1)
    v_mfma_f32_32x32x16_bf16 v[16:31], v[80:83], v[56:59], v[16:31]
    buffer_load_dwordx4 v[80:83], v3, s[8:11], s30 offen offset:0
    v_mfma_f32_32x32x16_bf16 v[32:47], v[84:87], v[56:59], v[32:47]
    buffer_load_dwordx4 v[84:87], v3, s[8:11], s30 offen offset:1024
    s_add_u32 s30, s30, 11264
    s_waitcnt lgkmcnt(0)
    v_mfma_f32_32x32x16_bf16 v[16:31], v[88:91], v[60:63], v[16:31]
    buffer_load_dwordx4 v[88:91], v3, s[8:11], s30 offen offset:0
    v_mfma_f32_32x32x16_bf16 v[32:47], v[92:95], v[60:63], v[32:47]
    buffer_load_dwordx4 v[92:95], v3, s[8:11], s30 offen offset:1024
    s_add_u32 s30, s30, 11264
    s_add_u32 m0, s33, 0
    s_nop 0
    buffer_load_dwordx4 v8, s[60:63], s29 offen lds
    s_add_u32 m0, s33, 1024
    s_nop 0
    buffer_load_dwordx4 v9, s[60:63], s29 offen lds
    s_add_u32 m0, s33, 2048
    s_nop 0
    buffer_load_dwordx4 v10, s[60:63], s29 offen lds
    s_add_u32 m0, s33, 3072
    s_nop 0
    buffer_load_dwordx4 v11, s[60:63], s29 offen lds
    s_add_u32 s29, s29, 128
    s_waitcnt vmcnt(24)
    ds_read_b128 v[48:51], v12 offset:4096
    ds_read_b128 v[52:55], v13 offset:4096
    ds_read_b128 v[56:59], v14 offset:4096
    ds_read_b128 v[60:63], v15 offset:4096
    s_waitcnt lgkmcnt(3)
    v_mfma_f32_32x32x16_bf16 v[16:31], v[96:99], v[48:51], v[16:31]
    buffer_load_dwordx4 v[96:99], v3, s[8:11], s30 offen offset:0
    v_mfma_f32_32x32x16_bf16 v[32:47], v[100:103], v[48:51], v[32:47]
    buffer_load_dwordx4 v[100:103], v3, s[8:11], s30 offen offset:1024
    s_add_u32 s30, s30, 11264
    s_waitcnt lgkmcnt(2)
    v_mfma_f32_32x32x16_bf16 v[16:31], v[104:107], v[52:55], v[16:31]
    buffer_load_dwordx4 v[104:107], v3, s[8:11], s30 offen offset:0
    v_mfma_f32_32x32x16_bf16 v[32:47], v[108:111], v[52:55], v[32:47]
    buffer_load_dwordx4 v[108:111], v3, s[8:11], s30 offen offset:1024
    s_add_u32 s30, s30, 11264
    s_waitcnt lgkmcnt(1)
    v_mfma_f32_32x32x16_bf16 v[16:31], v[112:115], v[56:59], v[16:31]
    buffer_load_dwordx4 v[112:115], v3, s[8:11], s30 offen offset:0
    v_mfma_f32_32x32x16_bf16 v[32:47], v[116:119], v[56:59], v[32:47]
    buffer_load_dwordx4 v[116:119], v3, s[8:11], s30 offen offset:1024
    s_add_u32 s30, s30, 11264
    s_waitcnt lgkmcnt(0)
    v_mfma_f32_32x32x16_bf16 v[16:31], v[120:123], v[60:63], v[16:31]
    buffer_load_dwordx4 v[120:123], v3, s[8:11], s30 offen offset:0
    v_mfma_f32_32x32x16_bf16 v[32:47], v[124:127], v[60:63], v[32:47]
    buffer_load_dwordx4 v[124:127], v3, s[8:11], s30 offen offset:1024
    s_add_u32 s30, s30, 11264
    s_add_u32 m0, s33, 4096
    s_nop 0
    buffer_load_dwordx4 v8, s[60:63], s29 offen lds
    s_add_u32 m0, s33, 5120
    s_nop 0
    buffer_load_dwordx4 v9, s[60:63], s29 offen lds
    s_add_u32 m0, s33, 6144
    s_nop 0
    buffer_load_dwordx4 v10, s[60:63], s29 offen lds
    s_add_u32 m0, s33, 7168
    s_nop 0
    buffer_load_dwordx4 v11, s[60:63], s29 offen lds
    s_add_u32 s29, s29, 128
    s_waitcnt vmcnt(24)
    ds_read_b128 v[48:51], v12 offset:8192
    ds_read_b128 v[52:55], v13 offset:8192
    ds_read_b128 v[56:59], v14 offset:8192
    ds_read_b128 v[60:63], v15 offset:8192
    s_waitcnt lgkmcnt(3)
    v_mfma_f32_32x32x16_bf16 v[16:31], v[128:131], v[48:51], v[16:31]
    buffer_load_dwordx4 v[128:131], v3, s[8:11], s30 offen offset:0
    v_mfma_f32_32x32x16_bf16 v[32:47], v[132:135], v[48:51], v[32:47]
    buffer_load_dwordx4 v[132:135], v3, s[8:11], s30 offen offset:1024
    s_add_u32 s30, s30, 11264
    s_waitcnt lgkmcnt(2)
    v_mfma_f32_32x32x16_bf16 v[16:31], v[136:139], v[52:55], v[16:31]
    buffer_load_dwordx4 v[136:139], v3, s[8:11], s30 offen offset:0
    v_mfma_f32_32x32x16_bf16 v[32:47], v[140:143], v[52:55], v[32:47]
    buffer_load_dwordx4 v[140:143], v3, s[8:11], s30 offen offset:1024
    s_add_u32 s30, s30, 11264
    s_waitcnt lgkmcnt(1)
    v_mfma_f32_32x32x16_bf16 v[16:31], v[144:147], v[56:59], v[16:31]
    buffer_load_dwordx4 v[144:147], v3, s[8:11], s30 offen offset:0
    v_mfma_f32_32x32x16_bf16 v[32:47], v[148:151], v[56:59], v[32:47]
    buffer_load_dwordx4 v[148:151], v3, s[8:11], s30 offen offset:1024
    s_add_u32 s30, s30, 11264
    s_waitcnt lgkmcnt(0)
    v_mfma_f32_32x32x16_bf16 v[16:31], v[152:155], v[60:63], v[16:31]
    buffer_load_dwordx4 v[152:155], v3, s[8:11], s30 offen offset:0
    v_mfma_f32_32x32x16_bf16 v[32:47], v[156:159], v[60:63], v[32:47]
    buffer_load_dwordx4 v[156:159], v3, s[8:11], s30 offen offset:1024
    s_add_u32 s30, s30, 11264
    s_add_u32 m0, s33, 8192
    s_nop 0
    buffer_load_dwordx4 v8, s[60:63], s29 offen lds
    s_add_u32 m0, s33, 9216
    s_nop 0
    buffer_load_dwordx4 v9, s[60:63], s29 offen lds
    s_add_u32 m0, s33, 10240
    s_nop 0
    buffer_load_dwordx4 v10, s[60:63], s29 offen lds
    s_add_u32 m0, s33, 11264
    s_nop 0
    buffer_load_dwordx4 v11, s[60:63], s29 offen lds
    s_add_u32 s29, s29, 128
    s_add_u32 s42, s42, 1
    s_cmp_lt_u32 s42, 5
    s_cbranch_scc1 KF_LOOP
    s_waitcnt vmcnt(24)
    ds_read_b128 v[48:51], v12
    ds_read_b128 v[52:55], v13
    ds_read_b128 v[56:59], v14
    ds_read_b128 v[60:63], v15
    s_waitcnt lgkmcnt(3)
    v_mfma_f32_32x32x16_bf16 v[16:31], v[64:67], v[48:51], v[16:31]
    v_mfma_f32_32x32x16_bf16 v[32:47], v[68:71], v[48:51], v[32:47]
    s_waitcnt lgkmcnt(2)
    v_mfma_f32_32x32x16_bf16 v[16:31], v[72:75], v[52:55], v[16:31]
    v_mfma_f32_32x32x16_bf16 v[32:47], v[76:79], v[52:55], v[32:47]
    s_waitcnt lgkmcnt(1)
    v_mfma_f32_32x32x16_bf16 v[16:31], v[80:83], v[56:59], v[16:31]
    v_mfma_f32_32x32x16_bf16 v[32:47], v[84:87], v[56:59], v[32:47]
    s_waitcnt lgkmcnt(0)
    v_mfma_f32_32x32x16_bf16 v[16:31], v[88:91], v[60:63], v[16:31]
    v_mfma_f32_32x32x16_bf16 v[32:47], v[92:95], v[60:63], v[32:47]
    s_cmp_eq_u32 s23, 0
    s_cbranch_scc0 KF_NO65
    s_waitcnt vmcnt(12)
    v_mfma_f32_32x32x16_bf16 v[16:31], v[96:99], v[164:167], v[16:31]
    v_mfma_f32_32x32x16_bf16 v[32:47], v[100:103], v[164:167], v[32:47]
KF_NO65:
    s_setprio 3
    s_waitcnt vmcnt(0)
    s_nop 15
    ds_write_b128 v160, v[16:19] offset:0
    ds_write_b128 v160, v[20:23] offset:1024
    ds_write_b128 v160, v[24:27] offset:2048
    ds_write_b128 v160, v[28:31] offset:3072
    ds_write_b128 v160, v[32:35] offset:4096
    ds_write_b128 v160, v[36:39] offset:5120
    ds_write_b128 v160, v[40:43] offset:6144
    ds_write_b128 v160, v[44:47] offset:7168
    s_waitcnt lgkmcnt(0)
    v_mov_b32 v146, 1
    ds_write_b32 v6, v146
KF_S1:
    ds_read_b32 v147, v7
    s_waitcnt lgkmcnt(0)
    v_cmp_le_u32 vcc, 1, v147
    s_nop 0
    s_cmp_eq_u64 vcc, exec
    s_cbranch_scc1 KF_S1_X
    s_sleep 4
    s_branch KF_S1
KF_S1_X:
    ds_read_b128 v[48:51], v161 offset:0
    ds_read_b128 v[52:55], v161 offset:64
    ds_read_b128 v[56:59], v161 offset:128
    ds_read_b128 v[60:63], v161 offset:192
    ds_read_b128 v[64:67], v161 offset:16384
    ds_read_b128 v[68:71], v161 offset:16448
    ds_read_b128 v[72:75], v161 offset:16512
    ds_read_b128 v[76:79], v161 offset:16576
    s_waitcnt lgkmcnt(0)
    v_mov_b32 v146, 2
    ds_write_b32 v6, v146
    v_sub_f32 v80, v48, v64
    v_add_f32 v96, v48, v64
    v_sub_f32 v81, v49, v65
    v_add_f32 v97, v49, v65
    v_sub_f32 v82, v50, v66
    v_add_f32 v98, v50, v66
    v_sub_f32 v83, v51, v67
    v_add_f32 v99, v51, v67
    v_sub_f32 v84, v52, v68
    v_add_f32 v100, v52, v68
    v_sub_f32 v85, v53, v69
    v_add_f32 v101, v53, v69
    v_sub_f32 v86, v54, v70
    v_add_f32 v102, v54, v70
    v_sub_f32 v87, v55, v71
    v_add_f32 v103, v55, v71
    v_sub_f32 v88, v56, v72
    v_add_f32 v104, v56, v72
    v_sub_f32 v89, v57, v73
    v_add_f32 v105, v57, v73
    v_sub_f32 v90, v58, v74
    v_add_f32 v106, v58, v74
    v_sub_f32 v91, v59, v75
    v_add_f32 v107, v59, v75
    v_sub_f32 v92, v60, v76
    v_add_f32 v108, v60, v76
    v_sub_f32 v93, v61, v77
    v_add_f32 v109, v61, v77
    v_sub_f32 v94, v62, v78
    v_add_f32 v110, v62, v78
    v_sub_f32 v95, v63, v79
    v_add_f32 v111, v63, v79
    s_mov_b64 exec, s[64:65]
    buffer_store_dwordx4 v[80:83], v162, s[8:11], s35 offen sc1
    buffer_store_dwordx4 v[96:99], v162, s[8:11], s36 offen sc1
    s_add_u32 s35, s35, 5632
    s_add_u32 s36, s36, 5632
    buffer_store_dwordx4 v[84:87], v162, s[8:11], s35 offen sc1
    buffer_store_dwordx4 v[100:103], v162, s[8:11], s36 offen sc1
    s_add_u32 s35, s35, 5632
    s_add_u32 s36, s36, 5632
    buffer_store_dwordx4 v[88:91], v162, s[8:11], s35 offen sc1
    buffer_store_dwordx4 v[104:107], v162, s[8:11], s36 offen sc1
    s_add_u32 s35, s35, 5632
    s_add_u32 s36, s36, 5632
    buffer_store_dwordx4 v[92:95], v162, s[8:11], s35 offen sc1
    buffer_store_dwordx4 v[108:111], v162, s[8:11], s36 offen sc1
    s_add_u32 s35, s35, 5632
    s_add_u32 s36, s36, 5632
    s_lshl_b32 s34, s25, 7
    s_lshl_b32 s35, s26, 4
    s_add_u32 s34, s34, s35
    s_lshl_b32 s35, s23, 2
    s_add_u32 s34, s34, s35
    s_add_u32 s34, s34, 8691712
    s_mov_b64 exec, 1
    v_mov_b32 v4, 0
    v_mov_b32 v5, 1
    s_waitcnt vmcnt(0) lgkmcnt(0)
    buffer_store_dword v5, v4, s[8:11], s34 offen sc1
    s_mov_b64 exec, -1
    s_branch K2_AUXEND
KF_NOJOB:
    v_mov_b32 v146, 2
    ds_write_b32 v6, v146
    s_waitcnt vmcnt(0) lgkmcnt(0)
    s_barrier
K2_AUXEND:
K2_EXIT:
    s_endpgm
K2_CODE_END:
.section .rodata,"a"
.p2align 6
.amdhsa_kernel gated_mix__spectral_fnet__mha_block__prompt_kernel
  .amdhsa_next_free_vgpr 168
  .amdhsa_next_free_sgpr 96
  .amdhsa_accum_offset 168
  .amdhsa_group_segment_fixed_size 0
  .amdhsa_kernarg_size 96
  .amdhsa_user_sgpr_count 2
  .amdhsa_user_sgpr_kernarg_segment_ptr 1
  .amdhsa_system_sgpr_workgroup_id_x 1
.end_amdhsa_kernel
```
